```python
import torch

def _softmax(x, axis=-1):
    return torch.softmax(x, dim=axis)

def _gelu(x):
    return torch.nn.functional.gelu(x, approximate='tanh')

def _silu(x):
    return torch.nn.functional.silu(x)

def _sigmoid(x):
    return torch.sigmoid(x)

def _layernorm(x, axis=-1, eps=1e-05):
    m = x.mean(dim=axis, keepdim=True)
    v = x.var(dim=axis, keepdim=True, unbiased=False)
    return (x - m) / torch.sqrt(v + eps)

def _scatter_add(tgt, idx, src, axis=0):
    return tgt.clone().index_add_(axis, idx, src)

def _segment_sum(src, seg, n):
    out = torch.zeros((n,) + src.shape[1:], dtype=src.dtype)
    return out.index_add_(0, seg, src)

def _pad(x, pw):
    flat = tuple((v for pair in reversed(pw) for v in pair))
    return torch.nn.functional.pad(x, flat)
kernel_name = 'adaLN_cond__mha_block_cached__mixer_channel_mlp__decode'

def setup_inputs():

    _w = lambda a: (lambda t: t.to(torch.bfloat16) if t.is_floating_point() else t)(torch.as_tensor(a))

    def _A_setup():
        B, Sq, D = (1, 1, 512)
        H, Sk, Dh = (32, 4096, 128)
        return {'x': _w((lambda *s: torch.randn(*s, dtype=torch.bfloat16) * 0.1)(B, Sq, D)), 'k_cache': _w((lambda *s: torch.randn(*s, dtype=torch.bfloat16) * 0.8)(B, H, Sk, Dh)), 'v_cache': _w((lambda *s: torch.randn(*s, dtype=torch.bfloat16) * 0.8)(B, H, Sk, Dh)), 'wq': _w((lambda *s: torch.randn(*s, dtype=torch.bfloat16) * 0.8)(D, H * Dh) * D ** (-0.5)), 'wo': _w((lambda *s: torch.randn(*s, dtype=torch.bfloat16) * 0.8)(H * Dh, D) * (H * Dh) ** (-0.5))}
    _A_in = _A_setup()

    def _B_setup():
        B, S, D, F = (1, 1, 512, 1376)
        return {'x': _w((lambda *s: torch.randn(*s, dtype=torch.bfloat16) * 0.1)(B, S, D)), 'w1': _w((lambda *s: torch.randn(*s, dtype=torch.bfloat16) * 3.2)(D, F) * D ** (-0.5)), 'b1': _w((lambda *s: torch.randn(*s, dtype=torch.bfloat16) * 3.2)(F)), 'w2': _w((lambda *s: torch.randn(*s, dtype=torch.bfloat16) * 3.2)(F, D) * F ** (-0.5)), 'b2': _w((lambda *s: torch.randn(*s, dtype=torch.bfloat16) * 3.2)(D))}
    _B_in = _B_setup()
    return {'A_x': _A_in['x'], 'A_k_cache': _A_in['k_cache'], 'A_v_cache': _A_in['v_cache'], 'A_wq': _A_in['wq'], 'A_wo': _A_in['wo'], 'B_x': _B_in['x'], 'B_w1': _B_in['w1'], 'B_b1': _B_in['b1'], 'B_w2': _B_in['w2'], 'B_b2': _B_in['b2'], 'c': _w((lambda *s: torch.randn(*s, dtype=torch.bfloat16) * 0.4)(1, 512) * 8.0), 'w_mod': _w((lambda *s: torch.randn(*s, dtype=torch.bfloat16) * 0.4)(512, 6 * 512) * 512 ** (-0.5) * 8.0)}

def reference(A_x, A_k_cache, A_v_cache, A_wq, A_wo, B_x, B_w1, B_b1, B_w2, B_b2, c, w_mod):

    def _A_ref(x, k_cache, v_cache, wq, wo):
        B, Sq, D = x.shape
        H, Dh = (32, 128)
        q = (lambda x, *d: x.permute(*d))((x @ wq).reshape(B, Sq, H, Dh), 0, 2, 1, 3)
        scores = torch.einsum('bhqd,bhkd->bhqk', q, k_cache) * Dh ** (-0.5)
        p = _softmax(scores, axis=-1)
        o = torch.einsum('bhqk,bhkd->bhqd', p, v_cache)
        return (lambda x, *d: x.permute(*d))(o, 0, 2, 1, 3).reshape(B, Sq, H * Dh) @ wo

    def _B_ref(x, w1, b1, w2, b2):
        y = _layernorm(x, axis=-1)
        h = _gelu(torch.einsum('bsd,df->bsf', y, w1) + b1)
        return torch.einsum('bsf,fd->bsd', h, w2) + b2
    x = A_x
    mod = (_silu(c) @ w_mod).reshape(c.shape[0], 6, 1, -1)
    sa, ca, ga, sb, cb, gb = (mod[:, 0].clone(), mod[:, 1].clone(), mod[:, 2].clone(), mod[:, 3].clone(), mod[:, 4].clone(), mod[:, 5].clone())
    h = _layernorm(x, axis=-1) * (1 + ca) + sa
    x = x + ga * _A_ref(h, A_k_cache, A_v_cache, A_wq, A_wo)
    h = _layernorm(x, axis=-1) * (1 + cb) + sb
    x = x + gb * _B_ref(h, B_w1, B_b1, B_w2, B_b2)
    return x
```

```asm
; @launch grid=(256,1,1) block=(768,1,1) lds=49152
.amdgcn_target "amdgcn-amd-amdhsa--gfx950"
.text
.globl adaLN_cond__mha_block_cached__mixer_channel_mlp__decode_kernel
.p2align 8
.type adaLN_cond__mha_block_cached__mixer_channel_mlp__decode_kernel,@function
adaLN_cond__mha_block_cached__mixer_channel_mlp__decode_kernel:
L_start:
    s_load_dwordx16 s[16:31], s[0:1], 0
    s_load_dwordx8 s[32:39], s[0:1], 64
    v_cmp_gt_u32 vcc, 0x200, v0
    s_cmpk_ge_u32 s2, 256
    s_cbranch_scc1 L_end
    s_cbranch_vccz L_hinit0
    s_mul_i32 s54, s2, 0x101000
    s_and_b32 s54, s54, 0x1fc0000
    s_and_b32 s53, s2, 32
    s_lshl_b32 s53, s53, 6
    s_add_u32 s54, s54, s53
    v_and_b32 v1, 31, v0
    v_lshl_add_u32 v5, v1, 4, s54
    v_lshrrev_b32 v1, 5, v0
    v_lshl_add_u32 v5, v1, 12, v5
    s_waitcnt lgkmcnt(0)
    global_load_dwordx4 v[32:35], v5, s[18:19] nt
    s_and_b32 s58, s2, 0x84
    s_cmpk_eq_u32 s58, 0x80
    s_cbranch_scc1 L_sA
    global_load_dwordx4 v[36:39], v5, s[18:19] offset:512 nt
    global_load_dwordx4 v[40:43], v5, s[18:19] offset:1024 nt
L_sA:
    s_branch L_sgo
L_hinit0:
    s_load_dwordx2 s[44:45], s[0:1], 112
    s_load_dwordx2 s[40:41], s[0:1], 96
    v_lshrrev_b32 v1, 6, v0
    s_and_b32 s42, s2, 31
    s_lshr_b32 s43, s2, 5
    s_and_b32 s47, s2, 7
    s_lshr_b32 s48, s2, 3
    v_readfirstlane_b32 s3, v1
    s_lshl3_add_u32 s6, s42, s43
    v_and_b32 v1, 63, v0
    v_lshrrev_b32 v2, 4, v1
    v_and_b32 v3, 15, v1
    v_lshlrev_b32 v4, 4, v1
    s_mov_b32 s15, 0x20000
    s_movk_i32 s53, 0x2000
    v_mov_b32 v156, 0
    v_mov_b32 v149, 0
    s_mov_b32 s52, 0
    s_and_b32 s58, s2, 0x84
    s_xor_b32 s58, s58, 0x80
L_hinit:
    s_setprio 3
    s_cmp_eq_u32 s3, 8
    s_cbranch_scc0 L_hinit2
    s_lshl_b32 s54, s43, 6
    v_add_u32 v7, s54, v1
    v_lshlrev_b32 v7, 1, v7
    v_lshl_add_u32 v5, v2, 4, s54
    v_lshlrev_b32 v5, 13, v5
    v_lshlrev_b32 v6, 4, v3
    s_lshl_b32 s54, s42, 8
    v_add3_u32 v5, v5, v6, s54
    s_mov_b32 s14, 0x400000
    s_waitcnt lgkmcnt(0)
    s_load_dword s46, s[44:45], 0
    s_mov_b32 s12, s22
    s_mov_b32 s13, s23
    global_load_dwordx4 v[16:19], v4, s[16:17]
    global_load_ushort v14, v7, s[16:17]
    s_branch L_shared
L_hinit2:
    s_cmp_eq_u32 s3, 9
    s_cbranch_scc0 L_hnear
    s_cmp_lt_u32 s48, 8
    s_cbranch_scc1 L_hnear
    s_lshl_b32 s54, s47, 4
    s_sub_u32 s54, s54, 16
    s_cmp_eq_u32 s58, 0
    s_cbranch_scc1 L_svlow
    s_mul_i32 s54, s47, 24
    s_sub_u32 s54, s54, 8
    s_lshl_b32 s55, s47, 3
    s_add_u32 s55, s55, 56
    s_cmp_lt_u32 s47, 4
    s_cselect_b32 s54, s55, s54
L_svlow:
    s_add_u32 s59, s54, s48
    s_lshr_b32 s57, s59, 6
    s_lshl_b32 s55, s59, 3
    s_and_b32 s55, s55, 0x1c0
    s_and_b32 s56, s59, 7
    s_lshl_b32 s56, s56, 7
    s_sub_u32 s54, 4, s57
    s_and_b32 s54, s54, 3
    s_lshl_b32 s54, s54, 10
    s_add_u32 s56, s56, s54
    s_or_b32 s57, s57, 1
    s_lshl_b32 s57, s57, 10
    v_lshl_add_u32 v5, v2, 4, s55
    v_mul_u32_u24 v5, 6144, v5
    v_lshrrev_b32 v6, 3, v3
    v_mul_u32_u24 v6, s57, v6
    v_add3_u32 v5, v5, v6, s56
    v_and_b32 v6, 7, v3
    v_lshl_add_u32 v5, v6, 4, v5
    v_add_lshl_u32 v6, s55, v1, 1
    s_movk_i32 s53, 6144
    s_mov_b32 s14, 0x300000
    s_waitcnt lgkmcnt(0)
    s_load_dword s46, s[44:45], 0
    s_mov_b32 s12, s38
    s_mov_b32 s13, s39
    global_load_ushort v12, v6, s[36:37]
L_shared:
    buffer_load_dwordx4 v[32:35], v5, s[12:15], s52 offen nt
    s_add_u32 s52, s52, s53
    buffer_load_dwordx4 v[36:39], v5, s[12:15], s52 offen nt
    s_add_u32 s52, s52, s53
    buffer_load_dwordx4 v[40:43], v5, s[12:15], s52 offen nt
    s_add_u32 s52, s52, s53
    buffer_load_dwordx4 v[44:47], v5, s[12:15], s52 offen nt
    s_add_u32 s52, s52, s53
    buffer_load_dwordx4 v[48:51], v5, s[12:15], s52 offen nt
    s_add_u32 s52, s52, s53
    buffer_load_dwordx4 v[52:55], v5, s[12:15], s52 offen nt
    s_add_u32 s52, s52, s53
    buffer_load_dwordx4 v[56:59], v5, s[12:15], s52 offen nt
    s_add_u32 s52, s52, s53
    buffer_load_dwordx4 v[60:63], v5, s[12:15], s52 offen nt
    s_add_u32 s52, s52, s53
    buffer_load_dwordx4 v[64:67], v5, s[12:15], s52 offen nt
    s_add_u32 s52, s52, s53
    buffer_load_dwordx4 v[68:71], v5, s[12:15], s52 offen nt
    s_add_u32 s52, s52, s53
    buffer_load_dwordx4 v[72:75], v5, s[12:15], s52 offen nt
    s_add_u32 s52, s52, s53
    buffer_load_dwordx4 v[76:79], v5, s[12:15], s52 offen nt
    s_add_u32 s52, s52, s53
    buffer_load_dwordx4 v[80:83], v5, s[12:15], s52 offen nt
    s_add_u32 s52, s52, s53
    buffer_load_dwordx4 v[84:87], v5, s[12:15], s52 offen nt
    s_add_u32 s52, s52, s53
    buffer_load_dwordx4 v[88:91], v5, s[12:15], s52 offen nt
    s_add_u32 s52, s52, s53
    buffer_load_dwordx4 v[92:95], v5, s[12:15], s52 offen nt
    s_barrier
    s_branch L_hcont
L_hnear:
    v_mov_b32 v12, 0
    v_mov_b32 v13, 0
    v_mov_b32 v14, 256
    ds_write_b64 v14, v[12:13]
    ds_write_b64 v14, v[12:13] offset:8
    ds_write_b64 v14, v[12:13] offset:16
    s_waitcnt lgkmcnt(0)
    s_load_dword s46, s[44:45], 0
    s_barrier
    s_branch L_hother
L_sgo:
    s_barrier
    s_cbranch_scc0 L_sgo2
    global_load_dwordx4 v[36:39], v5, s[18:19] offset:512 nt
    global_load_dwordx4 v[40:43], v5, s[18:19] offset:1024 nt
L_sgo2:
    s_mov_b64 s[12:13], s[18:19]
    s_lshl_b32 s14, 1, 25
    s_mov_b32 s15, 0x20000
    v_mov_b32 v160, 0x100
    s_mov_b32 s57, 3
    s_waitcnt vmcnt(2)
L_sk_1:
    buffer_load_dwordx4 v[44:47], v5, s[12:15], 0 offen offset:1536 nt
    s_waitcnt vmcnt(2)
L_sk_2:
    s_mov_b32 s53, 65536
    buffer_load_dwordx4 v[48:51], v5, s[12:15], s53 offen offset:0 nt
    s_waitcnt vmcnt(2)
L_sk_3:
    buffer_load_dwordx4 v[52:55], v5, s[12:15], s53 offen offset:512 nt
    s_waitcnt vmcnt(2)
L_sk_4:
    buffer_load_dwordx4 v[56:59], v5, s[12:15], s53 offen offset:1024 nt
    s_waitcnt vmcnt(2)
L_sk_5:
    buffer_load_dwordx4 v[60:63], v5, s[12:15], s53 offen offset:1536 nt
    s_waitcnt vmcnt(2)
L_sk_6:
    s_mov_b32 s53, 131072
    buffer_load_dwordx4 v[64:67], v5, s[12:15], s53 offen offset:0 nt
    s_waitcnt vmcnt(2)
L_sk_7:
    buffer_load_dwordx4 v[68:71], v5, s[12:15], s53 offen offset:512 nt
    s_waitcnt vmcnt(2)
L_sk_8:
    buffer_load_dwordx4 v[72:75], v5, s[12:15], s53 offen offset:1024 nt
    ds_read_b32 v162, v160 offset:16
    s_waitcnt vmcnt(2) lgkmcnt(0)
    v_readfirstlane_b32 s56, v162
    s_nop 0
    s_cmp_eq_u32 s56, 0
    s_cselect_b32 s57, 2, 3
    s_cmp_eq_u32 s57, 3
    s_cbranch_scc1 L_sk_9
    s_waitcnt vmcnt(1)
L_sk_9:
    buffer_load_dwordx4 v[76:79], v5, s[12:15], s53 offen offset:1536 nt
    s_waitcnt vmcnt(2)
    s_cmp_eq_u32 s57, 3
    s_cbranch_scc1 L_sk_10
    s_waitcnt vmcnt(1)
L_sk_10:
    s_mov_b32 s53, 196608
    buffer_load_dwordx4 v[80:83], v5, s[12:15], s53 offen offset:0 nt
    s_waitcnt vmcnt(2)
    s_cmp_eq_u32 s57, 3
    s_cbranch_scc1 L_sk_11
    s_waitcnt vmcnt(1)
L_sk_11:
    buffer_load_dwordx4 v[84:87], v5, s[12:15], s53 offen offset:512 nt
    s_waitcnt vmcnt(2)
    s_cmp_eq_u32 s57, 3
    s_cbranch_scc1 L_sk_12
    s_waitcnt vmcnt(1)
L_sk_12:
    buffer_load_dwordx4 v[88:91], v5, s[12:15], s53 offen offset:1024 nt
    s_waitcnt vmcnt(2)
    s_cmp_eq_u32 s57, 3
    s_cbranch_scc1 L_sk_13
    s_waitcnt vmcnt(1)
L_sk_13:
    buffer_load_dwordx4 v[92:95], v5, s[12:15], s53 offen offset:1536 nt
    s_mov_b32 s12, s20
    s_mov_b32 s13, s21
    v_lshrrev_b32 v1, 6, v0
    s_nop 0
    v_readfirstlane_b32 s3, v1
    v_and_b32 v1, 63, v0
    v_lshrrev_b32 v2, 4, v1
    v_and_b32 v3, 15, v1
    v_and_b32 v6, 1, v1
    v_lshlrev_b32 v6, 4, v6
    v_mov_b32 v7, 0xffff
    v_lshlrev_b32 v6, v6, v7
    v_bfe_u32 v7, v1, 1, 2
    v_cmp_eq_u32 vcc, 0, v7
    s_nop 1
    v_cndmask_b32 v8, 0, v6, vcc
    v_cmp_eq_u32 vcc, 1, v7
    s_nop 1
    v_cndmask_b32 v9, 0, v6, vcc
    v_cmp_eq_u32 vcc, 2, v7
    s_nop 1
    v_cndmask_b32 v10, 0, v6, vcc
    v_cmp_eq_u32 vcc, 3, v7
    s_nop 1
    v_cndmask_b32 v11, 0, v6, vcc
    v_lshlrev_b32 v3, 4, v3
    s_mov_b32 s4, 0xcccccccc
    s_mov_b32 s5, 0xcccccccc
    s_mov_b32 s6, 0xaaaaaaaa
    s_mov_b32 s7, 0xaaaaaaaa
    v_lshlrev_b32 v161, 3, v2
    v_and_b32 v162, 7, v1
    v_add_lshl_u32 v161, v161, v162, 4
    s_lshl_b32 s54, s3, 9
    v_add_u32 v161, s54, v161
    s_mov_b32 s56, 0
    v_mov_b32 v160, 256
    v_mov_b32 v163, 1
    s_waitcnt vmcnt(3)
    s_cmp_eq_u32 s57, 4
    s_cbranch_scc1 L_dw_14
    s_waitcnt vmcnt(2)
    s_cmp_eq_u32 s57, 3
    s_cbranch_scc1 L_dw_14
    s_waitcnt vmcnt(1)
L_dw_14:
    buffer_load_dwordx4 v[96:99], v5, s[12:15], 0 offen offset:0 nt
    s_waitcnt vmcnt(3)
    s_cmp_eq_u32 s57, 4
    s_cbranch_scc1 L_dw_15
    s_waitcnt vmcnt(2)
    s_cmp_eq_u32 s57, 3
    s_cbranch_scc1 L_dw_15
    s_waitcnt vmcnt(1)
L_dw_15:
    buffer_load_dwordx4 v[100:103], v5, s[12:15], 0 offen offset:512 nt
    s_waitcnt vmcnt(3)
    s_cmp_eq_u32 s57, 4
    s_cbranch_scc1 L_dw_16
    s_waitcnt vmcnt(2)
    s_cmp_eq_u32 s57, 3
    s_cbranch_scc1 L_dw_16
    s_waitcnt vmcnt(1)
L_dw_16:
    buffer_load_dwordx4 v[104:107], v5, s[12:15], 0 offen offset:1024 nt
    s_waitcnt vmcnt(3)
    s_cmp_eq_u32 s57, 4
    s_cbranch_scc1 L_dw_17
    s_waitcnt vmcnt(2)
    s_cmp_eq_u32 s57, 3
    s_cbranch_scc1 L_dw_17
    s_waitcnt vmcnt(1)
L_dw_17:
    buffer_load_dwordx4 v[108:111], v5, s[12:15], 0 offen offset:1536 nt
    s_cmp_eq_u32 s56, 4
    s_cbranch_scc1 L_st_18
    s_mov_b32 s55, 4
    s_call_b64 s[58:59], L_step
L_st_18:
    s_waitcnt vmcnt(3)
    s_cmp_eq_u32 s57, 4
    s_cbranch_scc1 L_dw_19
    s_waitcnt vmcnt(2)
    s_cmp_eq_u32 s57, 3
    s_cbranch_scc1 L_dw_19
    s_waitcnt vmcnt(1)
L_dw_19:
    s_mov_b32 s53, 65536
    buffer_load_dwordx4 v[112:115], v5, s[12:15], s53 offen offset:0 nt
    s_cmp_eq_u32 s56, 4
    s_cbranch_scc1 L_st_20
    s_mov_b32 s55, 4
    s_call_b64 s[58:59], L_step
L_st_20:
    s_waitcnt vmcnt(3)
    s_cmp_eq_u32 s57, 4
    s_cbranch_scc1 L_dw_21
    s_waitcnt vmcnt(2)
    s_cmp_eq_u32 s57, 3
    s_cbranch_scc1 L_dw_21
    s_waitcnt vmcnt(1)
L_dw_21:
    buffer_load_dwordx4 v[116:119], v5, s[12:15], s53 offen offset:512 nt
    s_cmp_eq_u32 s56, 4
    s_cbranch_scc1 L_st_22
    s_mov_b32 s55, 4
    s_call_b64 s[58:59], L_step
L_st_22:
    s_waitcnt vmcnt(3)
    s_cmp_eq_u32 s57, 4
    s_cbranch_scc1 L_dw_23
    s_waitcnt vmcnt(2)
    s_cmp_eq_u32 s57, 3
    s_cbranch_scc1 L_dw_23
    s_waitcnt vmcnt(1)
L_dw_23:
    buffer_load_dwordx4 v[120:123], v5, s[12:15], s53 offen offset:1024 nt
    s_cmp_eq_u32 s56, 4
    s_cbranch_scc1 L_st_24
    s_mov_b32 s55, 3
    s_call_b64 s[58:59], L_step
L_st_24:
    s_waitcnt vmcnt(3)
    s_cmp_eq_u32 s57, 4
    s_cbranch_scc1 L_dw_25
    s_waitcnt vmcnt(2)
    s_cmp_eq_u32 s57, 3
    s_cbranch_scc1 L_dw_25
    s_waitcnt vmcnt(1)
L_dw_25:
    buffer_load_dwordx4 v[124:127], v5, s[12:15], s53 offen offset:1536 nt
    s_cmp_eq_u32 s56, 4
    s_cbranch_scc1 L_st_26
    s_mov_b32 s55, 3
    s_call_b64 s[58:59], L_step
L_st_26:
    s_waitcnt vmcnt(3)
    s_cmp_eq_u32 s57, 4
    s_cbranch_scc1 L_dw_27
    s_waitcnt vmcnt(2)
    s_cmp_eq_u32 s57, 3
    s_cbranch_scc1 L_dw_27
    s_waitcnt vmcnt(1)
L_dw_27:
    s_mov_b32 s53, 131072
    buffer_load_dwordx4 v[128:131], v5, s[12:15], s53 offen offset:0 nt
    s_cmp_eq_u32 s56, 4
    s_cbranch_scc1 L_st_28
    s_mov_b32 s55, 3
    s_call_b64 s[58:59], L_step
L_st_28:
    s_waitcnt vmcnt(3)
    s_cmp_eq_u32 s57, 4
    s_cbranch_scc1 L_dw_29
    s_waitcnt vmcnt(2)
    s_cmp_eq_u32 s57, 3
    s_cbranch_scc1 L_dw_29
    s_waitcnt vmcnt(1)
L_dw_29:
    buffer_load_dwordx4 v[132:135], v5, s[12:15], s53 offen offset:512 nt
    s_cmp_eq_u32 s56, 4
    s_cbranch_scc1 L_st_30
    s_mov_b32 s55, 2
    s_call_b64 s[58:59], L_step
L_st_30:
    s_waitcnt vmcnt(3)
    s_cmp_eq_u32 s57, 4
    s_cbranch_scc1 L_dw_31
    s_waitcnt vmcnt(2)
    s_cmp_eq_u32 s57, 3
    s_cbranch_scc1 L_dw_31
    s_waitcnt vmcnt(1)
L_dw_31:
    buffer_load_dwordx4 v[136:139], v5, s[12:15], s53 offen offset:1024 nt
    s_cmp_eq_u32 s56, 4
    s_cbranch_scc1 L_st_32
    s_mov_b32 s55, 2
    s_call_b64 s[58:59], L_step
L_st_32:
    s_waitcnt vmcnt(3)
    s_cmp_eq_u32 s57, 4
    s_cbranch_scc1 L_dw_33
    s_waitcnt vmcnt(2)
    s_cmp_eq_u32 s57, 3
    s_cbranch_scc1 L_dw_33
    s_waitcnt vmcnt(1)
L_dw_33:
    buffer_load_dwordx4 v[140:143], v5, s[12:15], s53 offen offset:1536 nt
    s_cmp_eq_u32 s56, 4
    s_cbranch_scc1 L_st_34
    s_mov_b32 s55, 2
    s_call_b64 s[58:59], L_step
L_st_34:
    s_waitcnt vmcnt(3)
    s_cmp_eq_u32 s57, 4
    s_cbranch_scc1 L_dw_35
    s_waitcnt vmcnt(2)
    s_cmp_eq_u32 s57, 3
    s_cbranch_scc1 L_dw_35
    s_waitcnt vmcnt(1)
L_dw_35:
    s_mov_b32 s53, 196608
    buffer_load_dwordx4 v[144:147], v5, s[12:15], s53 offen offset:0 nt
    s_cmp_eq_u32 s56, 4
    s_cbranch_scc1 L_st_36
    s_mov_b32 s55, 2
    s_call_b64 s[58:59], L_step
L_st_36:
    s_waitcnt vmcnt(3)
    s_cmp_eq_u32 s57, 4
    s_cbranch_scc1 L_dw_37
    s_waitcnt vmcnt(2)
    s_cmp_eq_u32 s57, 3
    s_cbranch_scc1 L_dw_37
    s_waitcnt vmcnt(1)
L_dw_37:
    buffer_load_dwordx4 v[148:151], v5, s[12:15], s53 offen offset:512 nt
    s_cmp_eq_u32 s56, 4
    s_cbranch_scc1 L_st_38
    s_mov_b32 s55, 2
    s_call_b64 s[58:59], L_step
L_st_38:
    s_waitcnt vmcnt(3)
    s_cmp_eq_u32 s57, 4
    s_cbranch_scc1 L_dw_39
    s_waitcnt vmcnt(2)
    s_cmp_eq_u32 s57, 3
    s_cbranch_scc1 L_dw_39
    s_waitcnt vmcnt(1)
L_dw_39:
    buffer_load_dwordx4 v[152:155], v5, s[12:15], s53 offen offset:1024 nt
    s_cmp_eq_u32 s56, 4
    s_cbranch_scc1 L_st_40
    s_mov_b32 s55, 2
    s_call_b64 s[58:59], L_step
L_st_40:
    s_waitcnt vmcnt(3)
    s_cmp_eq_u32 s57, 4
    s_cbranch_scc1 L_dw_41
    s_waitcnt vmcnt(2)
    s_cmp_eq_u32 s57, 3
    s_cbranch_scc1 L_dw_41
    s_waitcnt vmcnt(1)
L_dw_41:
    buffer_load_dwordx4 v[156:159], v5, s[12:15], s53 offen offset:1536 nt
    s_mov_b64 exec, 1
    ds_add_u32 v160, v163 offset:4
    s_mov_b64 exec, -1
    s_mov_b32 s51, 16777216
L_sfin:
    s_cmp_eq_u32 s56, 4
    s_cbranch_scc1 L_sdone
    s_call_b64 s[58:59], L_step
    s_sub_u32 s51, s51, 1
    s_cbranch_scc0 L_sfin
L_sdone:
    v_mfma_f32_16x16x32_bf16 v[28:31], v[96:99], v[32:35], 0
    v_mfma_f32_16x16x32_bf16 v[28:31], v[100:103], v[36:39], v[28:31]
    v_mfma_f32_16x16x32_bf16 v[28:31], v[104:107], v[40:43], v[28:31]
    v_mfma_f32_16x16x32_bf16 v[28:31], v[108:111], v[44:47], v[28:31]
    v_mfma_f32_16x16x32_bf16 v[28:31], v[112:115], v[48:51], v[28:31]
    v_mfma_f32_16x16x32_bf16 v[28:31], v[116:119], v[52:55], v[28:31]
    v_mfma_f32_16x16x32_bf16 v[28:31], v[120:123], v[56:59], v[28:31]
    v_mfma_f32_16x16x32_bf16 v[28:31], v[124:127], v[60:63], v[28:31]
    v_mfma_f32_16x16x32_bf16 v[28:31], v[128:131], v[64:67], v[28:31]
    v_mfma_f32_16x16x32_bf16 v[28:31], v[132:135], v[68:71], v[28:31]
    v_mfma_f32_16x16x32_bf16 v[28:31], v[136:139], v[72:75], v[28:31]
    v_mfma_f32_16x16x32_bf16 v[28:31], v[140:143], v[76:79], v[28:31]
    s_waitcnt vmcnt(3)
    v_mfma_f32_16x16x32_bf16 v[28:31], v[144:147], v[80:83], v[28:31]
    s_waitcnt vmcnt(2)
    v_mfma_f32_16x16x32_bf16 v[28:31], v[148:151], v[84:87], v[28:31]
    s_waitcnt vmcnt(1)
    v_mfma_f32_16x16x32_bf16 v[28:31], v[152:155], v[88:91], v[28:31]
    s_waitcnt vmcnt(0)
    v_mfma_f32_16x16x32_bf16 v[28:31], v[156:159], v[92:95], v[28:31]
    s_nop 7
    ds_write_b128 v161, v[28:31] offset:1024
    s_waitcnt lgkmcnt(0)
    s_barrier
    s_endpgm
L_step:
    s_cmp_eq_u32 s56, 2
    s_cbranch_scc1 L_st2
    s_cmp_eq_u32 s56, 3
    s_cbranch_scc1 L_st3
    ds_read_b32 v162, v160
    ds_read_b128 v[164:167], v3 offset:0
    s_waitcnt lgkmcnt(0)
    v_cmp_eq_u32 vcc, 0, v162
    s_cbranch_vccz L_st1
    s_setpc_b64 s[58:59]
L_st1:
    s_mov_b32 s57, s55
    v_dot2_f32_bf16 v12, v32, v164, 0
    v_dot2_f32_bf16 v13, v36, v164, 0
    v_dot2_f32_bf16 v14, v40, v164, 0
    v_dot2_f32_bf16 v15, v44, v164, 0
    v_dot2_f32_bf16 v16, v48, v164, 0
    v_dot2_f32_bf16 v17, v52, v164, 0
    v_dot2_f32_bf16 v18, v56, v164, 0
    v_dot2_f32_bf16 v19, v60, v164, 0
    v_dot2_f32_bf16 v20, v64, v164, 0
    v_dot2_f32_bf16 v21, v68, v164, 0
    v_dot2_f32_bf16 v22, v72, v164, 0
    v_dot2_f32_bf16 v23, v76, v164, 0
    v_dot2_f32_bf16 v24, v80, v164, 0
    v_dot2_f32_bf16 v25, v84, v164, 0
    v_dot2_f32_bf16 v26, v88, v164, 0
    v_dot2_f32_bf16 v27, v92, v164, 0
    v_dot2_f32_bf16 v12, v33, v165, v12
    v_dot2_f32_bf16 v13, v37, v165, v13
    v_dot2_f32_bf16 v14, v41, v165, v14
    v_dot2_f32_bf16 v15, v45, v165, v15
    v_dot2_f32_bf16 v16, v49, v165, v16
    v_dot2_f32_bf16 v17, v53, v165, v17
    v_dot2_f32_bf16 v18, v57, v165, v18
    v_dot2_f32_bf16 v19, v61, v165, v19
    v_dot2_f32_bf16 v20, v65, v165, v20
    v_dot2_f32_bf16 v21, v69, v165, v21
    v_dot2_f32_bf16 v22, v73, v165, v22
    v_dot2_f32_bf16 v23, v77, v165, v23
    v_dot2_f32_bf16 v24, v81, v165, v24
    v_dot2_f32_bf16 v25, v85, v165, v25
    v_dot2_f32_bf16 v26, v89, v165, v26
    v_dot2_f32_bf16 v27, v93, v165, v27
    v_dot2_f32_bf16 v12, v34, v166, v12
    v_dot2_f32_bf16 v13, v38, v166, v13
    v_dot2_f32_bf16 v14, v42, v166, v14
    v_dot2_f32_bf16 v15, v46, v166, v15
    v_dot2_f32_bf16 v16, v50, v166, v16
    v_dot2_f32_bf16 v17, v54, v166, v17
    v_dot2_f32_bf16 v18, v58, v166, v18
    v_dot2_f32_bf16 v19, v62, v166, v19
    v_dot2_f32_bf16 v20, v66, v166, v20
    v_dot2_f32_bf16 v21, v70, v166, v21
    v_dot2_f32_bf16 v22, v74, v166, v22
    v_dot2_f32_bf16 v23, v78, v166, v23
    v_dot2_f32_bf16 v24, v82, v166, v24
    v_dot2_f32_bf16 v25, v86, v166, v25
    v_dot2_f32_bf16 v26, v90, v166, v26
    v_dot2_f32_bf16 v27, v94, v166, v27
    v_dot2_f32_bf16 v12, v35, v167, v12
    v_dot2_f32_bf16 v13, v39, v167, v13
    v_dot2_f32_bf16 v14, v43, v167, v14
    v_dot2_f32_bf16 v15, v47, v167, v15
    v_dot2_f32_bf16 v16, v51, v167, v16
    v_dot2_f32_bf16 v17, v55, v167, v17
    v_dot2_f32_bf16 v18, v59, v167, v18
    v_dot2_f32_bf16 v19, v63, v167, v19
    v_dot2_f32_bf16 v20, v67, v167, v20
    v_dot2_f32_bf16 v21, v71, v167, v21
    v_dot2_f32_bf16 v22, v75, v167, v22
    v_dot2_f32_bf16 v23, v79, v167, v23
    v_dot2_f32_bf16 v24, v83, v167, v24
    v_dot2_f32_bf16 v25, v87, v167, v25
    v_dot2_f32_bf16 v26, v91, v167, v26
    v_dot2_f32_bf16 v27, v95, v167, v27
    s_mov_b32 s56, 2
    s_setpc_b64 s[58:59]
L_st2:
    v_add_f32_dpp v12, v12, v12 row_ror:8 row_mask:0xf bank_mask:0x3
    v_add_f32_dpp v13, v13, v13 row_ror:8 row_mask:0xf bank_mask:0x3
    v_add_f32_dpp v14, v14, v14 row_ror:8 row_mask:0xf bank_mask:0x3
    v_add_f32_dpp v15, v15, v15 row_ror:8 row_mask:0xf bank_mask:0x3
    v_add_f32_dpp v16, v16, v16 row_ror:8 row_mask:0xf bank_mask:0x3
    v_add_f32_dpp v17, v17, v17 row_ror:8 row_mask:0xf bank_mask:0x3
    v_add_f32_dpp v18, v18, v18 row_ror:8 row_mask:0xf bank_mask:0x3
    v_add_f32_dpp v19, v19, v19 row_ror:8 row_mask:0xf bank_mask:0x3
    v_add_f32_dpp v12, v20, v20 row_ror:8 row_mask:0xf bank_mask:0xc
    v_add_f32_dpp v13, v21, v21 row_ror:8 row_mask:0xf bank_mask:0xc
    v_add_f32_dpp v14, v22, v22 row_ror:8 row_mask:0xf bank_mask:0xc
    v_add_f32_dpp v15, v23, v23 row_ror:8 row_mask:0xf bank_mask:0xc
    v_add_f32_dpp v16, v24, v24 row_ror:8 row_mask:0xf bank_mask:0xc
    v_add_f32_dpp v17, v25, v25 row_ror:8 row_mask:0xf bank_mask:0xc
    v_add_f32_dpp v18, v26, v26 row_ror:8 row_mask:0xf bank_mask:0xc
    v_add_f32_dpp v19, v27, v27 row_ror:8 row_mask:0xf bank_mask:0xc
    v_add_f32_dpp v12, v12, v12 row_half_mirror row_mask:0xf bank_mask:0x5
    v_add_f32_dpp v13, v13, v13 row_half_mirror row_mask:0xf bank_mask:0x5
    v_add_f32_dpp v14, v14, v14 row_half_mirror row_mask:0xf bank_mask:0x5
    v_add_f32_dpp v15, v15, v15 row_half_mirror row_mask:0xf bank_mask:0x5
    v_add_f32_dpp v12, v16, v16 row_half_mirror row_mask:0xf bank_mask:0xa
    v_add_f32_dpp v13, v17, v17 row_half_mirror row_mask:0xf bank_mask:0xa
    v_add_f32_dpp v14, v18, v18 row_half_mirror row_mask:0xf bank_mask:0xa
    v_add_f32_dpp v15, v19, v19 row_half_mirror row_mask:0xf bank_mask:0xa
    v_cndmask_b32 v16, v12, v14, s[4:5]
    v_cndmask_b32 v17, v14, v12, s[4:5]
    v_cndmask_b32 v18, v13, v15, s[4:5]
    v_cndmask_b32 v19, v15, v13, s[4:5]
    v_add_f32_dpp v12, v17, v16 quad_perm:[2,3,0,1] row_mask:0xf bank_mask:0xf
    s_nop 0
    v_add_f32_dpp v13, v19, v18 quad_perm:[2,3,0,1] row_mask:0xf bank_mask:0xf
    v_cndmask_b32 v16, v12, v13, s[6:7]
    v_cndmask_b32 v17, v13, v12, s[6:7]
    s_nop 1
    v_add_f32_dpp v12, v17, v16 quad_perm:[1,0,3,2] row_mask:0xf bank_mask:0xf
    v_cvt_pk_bf16_f32 v12, v12, v12
    v_lshlrev_b32 v12, 16, v12
    v_mul_f32 v12, 0x3db504f3, v12
    v_cvt_pk_bf16_f32 v12, v12, v12
    v_lshlrev_b32 v12, 16, v12
    v_mov_b32 v14, v12
    s_nop 1
    v_max_f32_dpp v14, v14, v14 row_ror:8 row_mask:0xf bank_mask:0xf
    s_nop 1
    v_max_f32_dpp v14, v14, v14 row_ror:4 row_mask:0xf bank_mask:0xf
    s_nop 1
    v_max_f32_dpp v14, v14, v14 row_ror:2 row_mask:0xf bank_mask:0xf
    s_nop 1
    v_max_f32_dpp v14, v14, v14 row_ror:1 row_mask:0xf bank_mask:0xf
    v_mov_b32 v16, v14
    s_nop 1
    v_permlane16_swap_b32 v14, v16
    v_max_f32 v14, v14, v16
    v_mov_b32 v16, v14
    s_nop 1
    v_permlane32_swap_b32 v14, v16
    v_max_f32 v14, v14, v16
    v_sub_f32 v12, v12, v14
    v_mul_f32 v12, 0x3fb8aa3b, v12
    v_exp_f32 v12, v12
    s_nop 0
    v_mov_b32 v15, v12
    v_cvt_pk_bf16_f32 v13, v12, v12
    s_nop 0
    v_add_f32_dpp v15, v15, v15 row_ror:8 row_mask:0xf bank_mask:0xf
    s_nop 1
    v_add_f32_dpp v15, v15, v15 row_ror:4 row_mask:0xf bank_mask:0xf
    s_nop 1
    v_add_f32_dpp v15, v15, v15 row_ror:2 row_mask:0xf bank_mask:0xf
    s_nop 1
    v_add_f32_dpp v15, v15, v15 row_ror:1 row_mask:0xf bank_mask:0xf
    v_mov_b32 v16, v15
    s_nop 1
    v_permlane16_swap_b32 v15, v16
    v_add_f32 v15, v15, v16
    v_mov_b32 v16, v15
    s_nop 1
    v_permlane32_swap_b32 v15, v16
    v_add_f32 v15, v15, v16
    s_lshl_b32 s52, s3, 3
    v_mov_b32 v162, s52
    ds_write_b64 v162, v[14:15] offset:512
    s_mov_b64 exec, 1
    ds_add_u32 v160, v163 offset:8
    s_mov_b64 exec, -1
    s_mov_b32 s56, 3
    s_setpc_b64 s[58:59]
L_st3:
    v_and_b32_dpp v32, v13, v8 row_newbcast:0 row_mask:0xf bank_mask:0xf
    v_and_b32_dpp v33, v13, v9 row_newbcast:0 row_mask:0xf bank_mask:0xf
    v_and_b32_dpp v34, v13, v10 row_newbcast:0 row_mask:0xf bank_mask:0xf
    v_and_b32_dpp v35, v13, v11 row_newbcast:0 row_mask:0xf bank_mask:0xf
    v_and_b32_dpp v36, v13, v8 row_newbcast:1 row_mask:0xf bank_mask:0xf
    v_and_b32_dpp v37, v13, v9 row_newbcast:1 row_mask:0xf bank_mask:0xf
    v_and_b32_dpp v38, v13, v10 row_newbcast:1 row_mask:0xf bank_mask:0xf
    v_and_b32_dpp v39, v13, v11 row_newbcast:1 row_mask:0xf bank_mask:0xf
    v_and_b32_dpp v40, v13, v8 row_newbcast:2 row_mask:0xf bank_mask:0xf
    v_and_b32_dpp v41, v13, v9 row_newbcast:2 row_mask:0xf bank_mask:0xf
    v_and_b32_dpp v42, v13, v10 row_newbcast:2 row_mask:0xf bank_mask:0xf
    v_and_b32_dpp v43, v13, v11 row_newbcast:2 row_mask:0xf bank_mask:0xf
    v_and_b32_dpp v44, v13, v8 row_newbcast:3 row_mask:0xf bank_mask:0xf
    v_and_b32_dpp v45, v13, v9 row_newbcast:3 row_mask:0xf bank_mask:0xf
    v_and_b32_dpp v46, v13, v10 row_newbcast:3 row_mask:0xf bank_mask:0xf
    v_and_b32_dpp v47, v13, v11 row_newbcast:3 row_mask:0xf bank_mask:0xf
    v_and_b32_dpp v48, v13, v8 row_newbcast:4 row_mask:0xf bank_mask:0xf
    v_and_b32_dpp v49, v13, v9 row_newbcast:4 row_mask:0xf bank_mask:0xf
    v_and_b32_dpp v50, v13, v10 row_newbcast:4 row_mask:0xf bank_mask:0xf
    v_and_b32_dpp v51, v13, v11 row_newbcast:4 row_mask:0xf bank_mask:0xf
    v_and_b32_dpp v52, v13, v8 row_newbcast:5 row_mask:0xf bank_mask:0xf
    v_and_b32_dpp v53, v13, v9 row_newbcast:5 row_mask:0xf bank_mask:0xf
    v_and_b32_dpp v54, v13, v10 row_newbcast:5 row_mask:0xf bank_mask:0xf
    v_and_b32_dpp v55, v13, v11 row_newbcast:5 row_mask:0xf bank_mask:0xf
    v_and_b32_dpp v56, v13, v8 row_newbcast:6 row_mask:0xf bank_mask:0xf
    v_and_b32_dpp v57, v13, v9 row_newbcast:6 row_mask:0xf bank_mask:0xf
    v_and_b32_dpp v58, v13, v10 row_newbcast:6 row_mask:0xf bank_mask:0xf
    v_and_b32_dpp v59, v13, v11 row_newbcast:6 row_mask:0xf bank_mask:0xf
    v_and_b32_dpp v60, v13, v8 row_newbcast:7 row_mask:0xf bank_mask:0xf
    v_and_b32_dpp v61, v13, v9 row_newbcast:7 row_mask:0xf bank_mask:0xf
    v_and_b32_dpp v62, v13, v10 row_newbcast:7 row_mask:0xf bank_mask:0xf
    v_and_b32_dpp v63, v13, v11 row_newbcast:7 row_mask:0xf bank_mask:0xf
    v_and_b32_dpp v64, v13, v8 row_newbcast:8 row_mask:0xf bank_mask:0xf
    v_and_b32_dpp v65, v13, v9 row_newbcast:8 row_mask:0xf bank_mask:0xf
    v_and_b32_dpp v66, v13, v10 row_newbcast:8 row_mask:0xf bank_mask:0xf
    v_and_b32_dpp v67, v13, v11 row_newbcast:8 row_mask:0xf bank_mask:0xf
    v_and_b32_dpp v68, v13, v8 row_newbcast:9 row_mask:0xf bank_mask:0xf
    v_and_b32_dpp v69, v13, v9 row_newbcast:9 row_mask:0xf bank_mask:0xf
    v_and_b32_dpp v70, v13, v10 row_newbcast:9 row_mask:0xf bank_mask:0xf
    v_and_b32_dpp v71, v13, v11 row_newbcast:9 row_mask:0xf bank_mask:0xf
    v_and_b32_dpp v72, v13, v8 row_newbcast:10 row_mask:0xf bank_mask:0xf
    v_and_b32_dpp v73, v13, v9 row_newbcast:10 row_mask:0xf bank_mask:0xf
    v_and_b32_dpp v74, v13, v10 row_newbcast:10 row_mask:0xf bank_mask:0xf
    v_and_b32_dpp v75, v13, v11 row_newbcast:10 row_mask:0xf bank_mask:0xf
    v_and_b32_dpp v76, v13, v8 row_newbcast:11 row_mask:0xf bank_mask:0xf
    v_and_b32_dpp v77, v13, v9 row_newbcast:11 row_mask:0xf bank_mask:0xf
    v_and_b32_dpp v78, v13, v10 row_newbcast:11 row_mask:0xf bank_mask:0xf
    v_and_b32_dpp v79, v13, v11 row_newbcast:11 row_mask:0xf bank_mask:0xf
    v_and_b32_dpp v80, v13, v8 row_newbcast:12 row_mask:0xf bank_mask:0xf
    v_and_b32_dpp v81, v13, v9 row_newbcast:12 row_mask:0xf bank_mask:0xf
    v_and_b32_dpp v82, v13, v10 row_newbcast:12 row_mask:0xf bank_mask:0xf
    v_and_b32_dpp v83, v13, v11 row_newbcast:12 row_mask:0xf bank_mask:0xf
    v_and_b32_dpp v84, v13, v8 row_newbcast:13 row_mask:0xf bank_mask:0xf
    v_and_b32_dpp v85, v13, v9 row_newbcast:13 row_mask:0xf bank_mask:0xf
    v_and_b32_dpp v86, v13, v10 row_newbcast:13 row_mask:0xf bank_mask:0xf
    v_and_b32_dpp v87, v13, v11 row_newbcast:13 row_mask:0xf bank_mask:0xf
    v_and_b32_dpp v88, v13, v8 row_newbcast:14 row_mask:0xf bank_mask:0xf
    v_and_b32_dpp v89, v13, v9 row_newbcast:14 row_mask:0xf bank_mask:0xf
    v_and_b32_dpp v90, v13, v10 row_newbcast:14 row_mask:0xf bank_mask:0xf
    v_and_b32_dpp v91, v13, v11 row_newbcast:14 row_mask:0xf bank_mask:0xf
    v_and_b32_dpp v92, v13, v8 row_newbcast:15 row_mask:0xf bank_mask:0xf
    v_and_b32_dpp v93, v13, v9 row_newbcast:15 row_mask:0xf bank_mask:0xf
    v_and_b32_dpp v94, v13, v10 row_newbcast:15 row_mask:0xf bank_mask:0xf
    v_and_b32_dpp v95, v13, v11 row_newbcast:15 row_mask:0xf bank_mask:0xf
    s_mov_b32 s56, 4
    s_setpc_b64 s[58:59]
L_hother:
    s_sub_u32 s49, s3, 8
    s_min_u32 s52, s47, 3
    s_mul_i32 s27, s47, 5
    s_add_u32 s27, s27, s52
    s_add_u32 s50, s27, s48
    s_cmp_lt_u32 s47, 3
    s_cselect_b32 s52, 6, 5
    s_cmp_ge_u32 s48, s52
    s_cselect_b32 s50, 0xff, s50
    s_and_b32 s58, s48, 3
    s_and_b32 s52, s2, 0x87
    s_cmp_eq_u32 s52, 0x80
    s_cselect_b32 s58, s58, 0xff
    s_lshl_b32 s7, s47, 2
    s_and_b32 s52, s48, 3
    s_add_u32 s7, s7, s52
    s_lshl_b32 s7, s7, 3
    s_add_u32 s7, s7, s43
    s_lshl_b32 s7, s7, 7
    s_and_b32 s52, s7, 0x6000
    s_add_u32 s7, s7, s52
    s_add_u32 s7, s7, 655360
    s_mov_b32 s8, s44
    s_mov_b32 s9, s45
    s_mov_b32 s10, 1097728
    s_mov_b32 s11, 0x20000
    v_and_b32 v20, 1, v1
    v_lshlrev_b32 v20, 4, v20
    v_mov_b32 v21, 0xffff
    v_lshlrev_b32 v20, v20, v21
    v_bfe_u32 v21, v1, 1, 2
    v_cmp_eq_u32 vcc, 0, v21
    s_nop 1
    v_cndmask_b32 v8, 0, v20, vcc
    v_cmp_eq_u32 vcc, 1, v21
    s_nop 1
    v_cndmask_b32 v9, 0, v20, vcc
    v_cmp_eq_u32 vcc, 2, v21
    s_nop 1
    v_cndmask_b32 v10, 0, v20, vcc
    v_cmp_eq_u32 vcc, 3, v21
    s_nop 1
    v_cndmask_b32 v11, 0, v20, vcc
    s_waitcnt lgkmcnt(0)
    s_mul_i32 s46, s46, 0x9e3779b1
    s_add_u32 s46, s46, 0x7f4a7c15
    s_min_u32 s46, s46, -2
    s_cmp_eq_u32 s3, 11
    s_cbranch_scc1 L_prep
    s_cmp_eq_u32 s3, 10
    s_cbranch_scc1 L_u2
    s_cmp_ge_u32 s50, 43
    s_cbranch_scc1 L_prep
    s_lshl_b32 s52, s2, 7
L_probe0:
    s_add_u32 s54, s44, s52
    s_addc_u32 s55, s45, 0
    s_load_dword s70, s[54:55], 720896 glc
    s_load_dword s71, s[54:55], 729088 glc
    s_load_dword s70, s[54:55], 737280 glc
    s_load_dword s71, s[54:55], 745472 glc
    s_load_dword s70, s[54:55], 753664 glc
    s_load_dword s71, s[54:55], 761856 glc
    s_load_dword s70, s[54:55], 770048 glc
    s_load_dword s71, s[54:55], 778240 glc
    s_mov_b32 s62, -1
    s_mov_b32 s63, -1
    s_mov_b32 s53, 4
L_probe:
    s_and_b32 s52, s53, 3
    s_lshl_b32 s52, s52, 14
    s_add_u32 s52, s52, 720896
    s_add_u32 s56, s52, 8192
    s_waitcnt lgkmcnt(0)
    s_memtime s[64:65]
    s_waitcnt lgkmcnt(0)
    s_load_dword s60, s[54:55], s52 glc
    s_waitcnt lgkmcnt(0)
    s_memtime s[66:67]
    s_waitcnt lgkmcnt(0)
    s_load_dword s61, s[54:55], s56 glc
    s_waitcnt lgkmcnt(0)
    s_memtime s[68:69]
    s_waitcnt lgkmcnt(0)
    s_sub_u32 s68, s68, s66
    s_sub_u32 s66, s66, s64
    s_min_u32 s62, s62, s66
    s_min_u32 s63, s63, s68
    s_sub_u32 s53, s53, 1
    s_cbranch_scc0 L_probe
    s_cmp_lt_u32 s63, s62
    s_cselect_b32 s52, 0x2001, 1
    v_mov_b32 v12, s52
    v_mov_b32 v13, 268
    ds_write_b32 v13, v12
    s_branch L_prep
L_u2:
    s_add_u32 s52, s48, 32
    s_lshl_b32 s52, s52, 7
    s_cmp_lt_u32 s58, 4
    s_cbranch_scc1 L_probe0
    s_cmp_ge_u32 s48, 8
    s_cbranch_scc1 L_w1pf
    s_cmp_lt_u32 s48, 6
    s_cbranch_scc1 L_prep
    s_and_b32 s56, s2, 15
    s_lshl_b32 s53, s56, 13
    s_add_u32 s53, s53, 131072
    v_add_u32 v6, s53, v4
    v_mov_b32 v12, 272
    s_mov_b32 s51, 16777216
L_lw_42:
    ds_read_b32 v13, v12
    s_waitcnt lgkmcnt(0)
    v_cmp_gt_u32 vcc, 1, v13
    s_cbranch_vccz L_lok_43
    s_sleep 4
    s_sub_u32 s51, s51, 1
    s_cbranch_scc0 L_lw_42
L_lok_43:
    s_add_u32 s54, s44, s53
    s_addc_u32 s55, s45, 0
    s_mov_b32 s51, 15
L_spoll_44:
    s_load_dword s60, s[54:55], 60
    s_load_dword s61, s[54:55], 1084
    s_load_dword s62, s[54:55], 2108
    s_load_dword s63, s[54:55], 3132
    s_load_dword s64, s[54:55], 4156
    s_load_dword s65, s[54:55], 5180
    s_load_dword s66, s[54:55], 6204
    s_load_dword s67, s[54:55], 7228
    s_add_u32 s54, s54, 64
    s_addc_u32 s55, s55, 0
    s_waitcnt lgkmcnt(0)
    s_xor_b32 s60, s60, s46
    s_xor_b32 s61, s61, s46
    s_or_b32 s60, s60, s61
    s_xor_b32 s62, s62, s46
    s_or_b32 s60, s60, s62
    s_xor_b32 s63, s63, s46
    s_or_b32 s60, s60, s63
    s_xor_b32 s64, s64, s46
    s_or_b32 s60, s60, s64
    s_xor_b32 s65, s65, s46
    s_or_b32 s60, s60, s65
    s_xor_b32 s66, s66, s46
    s_or_b32 s60, s60, s66
    s_xor_b32 s67, s67, s46
    s_or_b32 s60, s60, s67
    s_cbranch_scc0 L_sok_45
    s_sleep 16
    s_sub_u32 s51, s51, 1
    s_cbranch_scc0 L_spoll_44
L_sok_45:
    s_mov_b32 s51, 2097152
L_poll_46:
    buffer_load_dwordx4 v[96:99], v6, s[8:11], 0 offen offset:0 sc1
    buffer_load_dwordx4 v[100:103], v6, s[8:11], 0 offen offset:1024 sc1
    buffer_load_dwordx4 v[104:107], v6, s[8:11], 0 offen offset:2048 sc1
    buffer_load_dwordx4 v[108:111], v6, s[8:11], 0 offen offset:3072 sc1
    s_mov_b32 s52, 4096
    buffer_load_dwordx4 v[112:115], v6, s[8:11], s52 offen offset:0 sc1
    s_mov_b32 s52, 4096
    buffer_load_dwordx4 v[116:119], v6, s[8:11], s52 offen offset:1024 sc1
    s_mov_b32 s52, 4096
    buffer_load_dwordx4 v[120:123], v6, s[8:11], s52 offen offset:2048 sc1
    s_mov_b32 s52, 4096
    buffer_load_dwordx4 v[124:127], v6, s[8:11], s52 offen offset:3072 sc1
    s_waitcnt vmcnt(0)
    v_xor_b32 v15, s46, v97
    v_bitop3_b32 v15, v15, v99, s46 bitop3:0xf6
    v_bitop3_b32 v15, v15, v101, s46 bitop3:0xf6
    v_bitop3_b32 v15, v15, v103, s46 bitop3:0xf6
    v_bitop3_b32 v15, v15, v105, s46 bitop3:0xf6
    v_bitop3_b32 v15, v15, v107, s46 bitop3:0xf6
    v_bitop3_b32 v15, v15, v109, s46 bitop3:0xf6
    v_bitop3_b32 v15, v15, v111, s46 bitop3:0xf6
    v_bitop3_b32 v15, v15, v113, s46 bitop3:0xf6
    v_bitop3_b32 v15, v15, v115, s46 bitop3:0xf6
    v_bitop3_b32 v15, v15, v117, s46 bitop3:0xf6
    v_bitop3_b32 v15, v15, v119, s46 bitop3:0xf6
    v_bitop3_b32 v15, v15, v121, s46 bitop3:0xf6
    v_bitop3_b32 v15, v15, v123, s46 bitop3:0xf6
    v_bitop3_b32 v15, v15, v125, s46 bitop3:0xf6
    v_bitop3_b32 v15, v15, v127, s46 bitop3:0xf6
    v_cmp_ne_u32 vcc, 0, v15
    s_cbranch_vccz L_ok_47
    s_sleep 8
    s_sub_u32 s51, s51, 1
    s_cbranch_scc0 L_poll_46
L_ok_47:
    v_add_f32 v24, v96, v100
    v_add_f32 v26, v98, v102
    v_add_f32 v24, v24, v104
    v_add_f32 v26, v26, v106
    v_add_f32 v24, v24, v108
    v_add_f32 v26, v26, v110
    v_add_f32 v24, v24, v112
    v_add_f32 v26, v26, v114
    v_add_f32 v24, v24, v116
    v_add_f32 v26, v26, v118
    v_add_f32 v24, v24, v120
    v_add_f32 v26, v26, v122
    v_add_f32 v24, v24, v124
    v_add_f32 v26, v26, v126
    v_cvt_pk_bf16_f32 v24, v24, v26
    v_mov_b32 v25, s46
    v_lshlrev_b32 v6, 3, v1
    s_lshl_b32 s53, s56, 9
    s_add_u32 s53, s53, 4096
    buffer_store_dwordx2 v[24:25], v6, s[8:11], s53 offen sc1
    s_branch L_prep
L_w1pf:
    s_branch L_prep
L_hcont:
    s_sub_u32 s49, s3, 8
    s_min_u32 s52, s47, 3
    s_mul_i32 s27, s47, 5
    s_add_u32 s27, s27, s52
    s_add_u32 s50, s27, s48
    s_cmp_lt_u32 s47, 3
    s_cselect_b32 s52, 6, 5
    s_cmp_ge_u32 s48, s52
    s_cselect_b32 s50, 0xff, s50
    s_and_b32 s58, s48, 3
    s_and_b32 s52, s2, 0x87
    s_cmp_eq_u32 s52, 0x80
    s_cselect_b32 s58, s58, 0xff
    s_lshl_b32 s7, s47, 2
    s_and_b32 s52, s48, 3
    s_add_u32 s7, s7, s52
    s_lshl_b32 s7, s7, 3
    s_add_u32 s7, s7, s43
    s_lshl_b32 s7, s7, 7
    s_and_b32 s52, s7, 0x6000
    s_add_u32 s7, s7, s52
    s_add_u32 s7, s7, 655360
    s_mov_b32 s8, s44
    s_mov_b32 s9, s45
    s_mov_b32 s10, 1097728
    s_mov_b32 s11, 0x20000
    v_and_b32 v20, 1, v1
    v_lshlrev_b32 v20, 4, v20
    v_mov_b32 v21, 0xffff
    v_lshlrev_b32 v20, v20, v21
    v_bfe_u32 v21, v1, 1, 2
    v_cmp_eq_u32 vcc, 0, v21
    s_nop 1
    v_cndmask_b32 v8, 0, v20, vcc
    v_cmp_eq_u32 vcc, 1, v21
    s_nop 1
    v_cndmask_b32 v9, 0, v20, vcc
    v_cmp_eq_u32 vcc, 2, v21
    s_nop 1
    v_cndmask_b32 v10, 0, v20, vcc
    v_cmp_eq_u32 vcc, 3, v21
    s_nop 1
    v_cndmask_b32 v11, 0, v20, vcc
    s_cmp_eq_u32 s3, 8
    s_cbranch_scc1 L_control
    s_waitcnt vmcnt(16)
    v_lshlrev_b32 v12, 16, v12
    s_mov_b32 s53, 0xbfb8aa3b
    v_mul_f32 v13, s53, v12
    v_fma_f32 v14, v12, s53, -v13
    v_fmac_f32 v14, 0xb2a57060, v12
    v_exp_f32 v13, v13
    v_mul_f32 v14, 0x3f317218, v14
    v_min_f32 v13, 0x7f000000, v13
    v_fmac_f32 v13, v13, v14
    v_add_f32 v13, 1.0, v13
    v_rcp_f32 v14, v13
    s_nop 0
    v_mul_f32 v15, v12, v14
    v_fma_f32 v12, -v15, v13, v12
    v_fmac_f32 v15, v12, v14
    v_cvt_pk_bf16_f32 v12, v15, v15
    s_nop 1
    v_and_b32_dpp v16, v12, v8 row_newbcast:0 row_mask:0xf bank_mask:0xf
    v_and_b32_dpp v17, v12, v9 row_newbcast:0 row_mask:0xf bank_mask:0xf
    v_and_b32_dpp v18, v12, v10 row_newbcast:0 row_mask:0xf bank_mask:0xf
    v_and_b32_dpp v19, v12, v11 row_newbcast:0 row_mask:0xf bank_mask:0xf
    v_and_b32_dpp v20, v12, v8 row_newbcast:1 row_mask:0xf bank_mask:0xf
    v_and_b32_dpp v21, v12, v9 row_newbcast:1 row_mask:0xf bank_mask:0xf
    v_and_b32_dpp v22, v12, v10 row_newbcast:1 row_mask:0xf bank_mask:0xf
    v_and_b32_dpp v23, v12, v11 row_newbcast:1 row_mask:0xf bank_mask:0xf
    s_waitcnt vmcnt(15)
    v_mfma_f32_16x16x32_bf16 v[28:31], v[32:35], v[16:19], 0
    v_and_b32_dpp v16, v12, v8 row_newbcast:2 row_mask:0xf bank_mask:0xf
    v_and_b32_dpp v17, v12, v9 row_newbcast:2 row_mask:0xf bank_mask:0xf
    v_and_b32_dpp v18, v12, v10 row_newbcast:2 row_mask:0xf bank_mask:0xf
    v_and_b32_dpp v19, v12, v11 row_newbcast:2 row_mask:0xf bank_mask:0xf
    s_waitcnt vmcnt(14)
    v_mfma_f32_16x16x32_bf16 v[28:31], v[36:39], v[20:23], v[28:31]
    v_and_b32_dpp v20, v12, v8 row_newbcast:3 row_mask:0xf bank_mask:0xf
    v_and_b32_dpp v21, v12, v9 row_newbcast:3 row_mask:0xf bank_mask:0xf
    v_and_b32_dpp v22, v12, v10 row_newbcast:3 row_mask:0xf bank_mask:0xf
    v_and_b32_dpp v23, v12, v11 row_newbcast:3 row_mask:0xf bank_mask:0xf
    s_waitcnt vmcnt(13)
    v_mfma_f32_16x16x32_bf16 v[28:31], v[40:43], v[16:19], v[28:31]
    v_and_b32_dpp v16, v12, v8 row_newbcast:4 row_mask:0xf bank_mask:0xf
    v_and_b32_dpp v17, v12, v9 row_newbcast:4 row_mask:0xf bank_mask:0xf
    v_and_b32_dpp v18, v12, v10 row_newbcast:4 row_mask:0xf bank_mask:0xf
    v_and_b32_dpp v19, v12, v11 row_newbcast:4 row_mask:0xf bank_mask:0xf
    s_waitcnt vmcnt(12)
    v_mfma_f32_16x16x32_bf16 v[28:31], v[44:47], v[20:23], v[28:31]
    v_and_b32_dpp v20, v12, v8 row_newbcast:5 row_mask:0xf bank_mask:0xf
    v_and_b32_dpp v21, v12, v9 row_newbcast:5 row_mask:0xf bank_mask:0xf
    v_and_b32_dpp v22, v12, v10 row_newbcast:5 row_mask:0xf bank_mask:0xf
    v_and_b32_dpp v23, v12, v11 row_newbcast:5 row_mask:0xf bank_mask:0xf
    s_waitcnt vmcnt(11)
    v_mfma_f32_16x16x32_bf16 v[28:31], v[48:51], v[16:19], v[28:31]
    v_and_b32_dpp v16, v12, v8 row_newbcast:6 row_mask:0xf bank_mask:0xf
    v_and_b32_dpp v17, v12, v9 row_newbcast:6 row_mask:0xf bank_mask:0xf
    v_and_b32_dpp v18, v12, v10 row_newbcast:6 row_mask:0xf bank_mask:0xf
    v_and_b32_dpp v19, v12, v11 row_newbcast:6 row_mask:0xf bank_mask:0xf
    s_waitcnt vmcnt(10)
    v_mfma_f32_16x16x32_bf16 v[28:31], v[52:55], v[20:23], v[28:31]
    v_and_b32_dpp v20, v12, v8 row_newbcast:7 row_mask:0xf bank_mask:0xf
    v_and_b32_dpp v21, v12, v9 row_newbcast:7 row_mask:0xf bank_mask:0xf
    v_and_b32_dpp v22, v12, v10 row_newbcast:7 row_mask:0xf bank_mask:0xf
    v_and_b32_dpp v23, v12, v11 row_newbcast:7 row_mask:0xf bank_mask:0xf
    s_waitcnt vmcnt(9)
    v_mfma_f32_16x16x32_bf16 v[28:31], v[56:59], v[16:19], v[28:31]
    v_and_b32_dpp v16, v12, v8 row_newbcast:8 row_mask:0xf bank_mask:0xf
    v_and_b32_dpp v17, v12, v9 row_newbcast:8 row_mask:0xf bank_mask:0xf
    v_and_b32_dpp v18, v12, v10 row_newbcast:8 row_mask:0xf bank_mask:0xf
    v_and_b32_dpp v19, v12, v11 row_newbcast:8 row_mask:0xf bank_mask:0xf
    s_waitcnt vmcnt(8)
    v_mfma_f32_16x16x32_bf16 v[28:31], v[60:63], v[20:23], v[28:31]
    v_and_b32_dpp v20, v12, v8 row_newbcast:9 row_mask:0xf bank_mask:0xf
    v_and_b32_dpp v21, v12, v9 row_newbcast:9 row_mask:0xf bank_mask:0xf
    v_and_b32_dpp v22, v12, v10 row_newbcast:9 row_mask:0xf bank_mask:0xf
    v_and_b32_dpp v23, v12, v11 row_newbcast:9 row_mask:0xf bank_mask:0xf
    s_waitcnt vmcnt(7)
    v_mfma_f32_16x16x32_bf16 v[28:31], v[64:67], v[16:19], v[28:31]
    v_and_b32_dpp v16, v12, v8 row_newbcast:10 row_mask:0xf bank_mask:0xf
    v_and_b32_dpp v17, v12, v9 row_newbcast:10 row_mask:0xf bank_mask:0xf
    v_and_b32_dpp v18, v12, v10 row_newbcast:10 row_mask:0xf bank_mask:0xf
    v_and_b32_dpp v19, v12, v11 row_newbcast:10 row_mask:0xf bank_mask:0xf
    s_waitcnt vmcnt(6)
    v_mfma_f32_16x16x32_bf16 v[28:31], v[68:71], v[20:23], v[28:31]
    v_and_b32_dpp v20, v12, v8 row_newbcast:11 row_mask:0xf bank_mask:0xf
    v_and_b32_dpp v21, v12, v9 row_newbcast:11 row_mask:0xf bank_mask:0xf
    v_and_b32_dpp v22, v12, v10 row_newbcast:11 row_mask:0xf bank_mask:0xf
    v_and_b32_dpp v23, v12, v11 row_newbcast:11 row_mask:0xf bank_mask:0xf
    s_waitcnt vmcnt(5)
    v_mfma_f32_16x16x32_bf16 v[28:31], v[72:75], v[16:19], v[28:31]
    v_and_b32_dpp v16, v12, v8 row_newbcast:12 row_mask:0xf bank_mask:0xf
    v_and_b32_dpp v17, v12, v9 row_newbcast:12 row_mask:0xf bank_mask:0xf
    v_and_b32_dpp v18, v12, v10 row_newbcast:12 row_mask:0xf bank_mask:0xf
    v_and_b32_dpp v19, v12, v11 row_newbcast:12 row_mask:0xf bank_mask:0xf
    s_waitcnt vmcnt(4)
    v_mfma_f32_16x16x32_bf16 v[28:31], v[76:79], v[20:23], v[28:31]
    v_and_b32_dpp v20, v12, v8 row_newbcast:13 row_mask:0xf bank_mask:0xf
    v_and_b32_dpp v21, v12, v9 row_newbcast:13 row_mask:0xf bank_mask:0xf
    v_and_b32_dpp v22, v12, v10 row_newbcast:13 row_mask:0xf bank_mask:0xf
    v_and_b32_dpp v23, v12, v11 row_newbcast:13 row_mask:0xf bank_mask:0xf
    s_waitcnt vmcnt(3)
    v_mfma_f32_16x16x32_bf16 v[28:31], v[80:83], v[16:19], v[28:31]
    v_and_b32_dpp v16, v12, v8 row_newbcast:14 row_mask:0xf bank_mask:0xf
    v_and_b32_dpp v17, v12, v9 row_newbcast:14 row_mask:0xf bank_mask:0xf
    v_and_b32_dpp v18, v12, v10 row_newbcast:14 row_mask:0xf bank_mask:0xf
    v_and_b32_dpp v19, v12, v11 row_newbcast:14 row_mask:0xf bank_mask:0xf
    s_waitcnt vmcnt(2)
    v_mfma_f32_16x16x32_bf16 v[28:31], v[84:87], v[20:23], v[28:31]
    v_and_b32_dpp v20, v12, v8 row_newbcast:15 row_mask:0xf bank_mask:0xf
    v_and_b32_dpp v21, v12, v9 row_newbcast:15 row_mask:0xf bank_mask:0xf
    v_and_b32_dpp v22, v12, v10 row_newbcast:15 row_mask:0xf bank_mask:0xf
    v_and_b32_dpp v23, v12, v11 row_newbcast:15 row_mask:0xf bank_mask:0xf
    s_waitcnt vmcnt(1)
    v_mfma_f32_16x16x32_bf16 v[28:31], v[88:91], v[16:19], v[28:31]
    s_waitcnt vmcnt(0)
    v_mfma_f32_16x16x32_bf16 v[28:31], v[92:95], v[20:23], v[28:31]
    s_mov_b32 s4, 0xff00ff00
    s_mov_b32 s5, 0xff00ff00
    s_and_b32 s52, s59, 7
    s_lshl_b32 s52, s52, 13
    s_bfe_u32 s53, s59, 0x30003
    s_lshl_b32 s53, s53, 10
    s_add_u32 s52, s52, s53
    s_lshr_b32 s53, s59, 6
    s_lshl_b32 s53, s53, 16
    s_add_u32 s52, s52, s53
    s_add_u32 s59, s52, 65536
    s_waitcnt lgkmcnt(0)
    s_mul_i32 s46, s46, 0x9e3779b1
    s_add_u32 s46, s46, 0x7f4a7c15
    s_min_u32 s46, s46, -2
    v_and_b32 v5, 1, v2
    v_lshlrev_b32 v5, 5, v5
    v_lshrrev_b32 v6, 1, v2
    v_lshl_add_u32 v5, v6, 4, v5
    v_add_lshl_u32 v5, v5, v3, 4
    v_permlane32_swap_b32 v28, v30
    v_permlane32_swap_b32 v29, v31
    v_cndmask_b32 v16, v28, v29, s[4:5]
    v_cndmask_b32 v18, v30, v31, s[4:5]
    v_mov_b32 v17, s46
    v_mov_b32 v19, s46
    buffer_store_dwordx4 v[16:19], v5, s[8:11], s59 offen sc1
    s_branch L_prep
L_control:
    v_mov_b32 v20, -1
    v_mov_b32 v21, -1
    v_mov_b32 v22, -1
    v_mov_b32 v23, -1
    s_lshl_b32 s53, s6, 10
    s_add_u32 s53, s53, 262144
    buffer_store_dwordx4 v[20:23], v4, s[8:11], s53 offen
    s_lshl_b32 s53, s6, 9
    s_add_u32 s53, s53, 524288
    s_mov_b32 exec_hi, 0
    buffer_store_dwordx4 v[20:23], v4, s[8:11], s53 offen sc1
    s_mov_b32 exec_lo, 0xff
    buffer_store_dwordx4 v[20:23], v4, s[8:11], s7 offen sc1
    s_add_u32 s53, s7, 8192
    buffer_store_dwordx4 v[20:23], v4, s[8:11], s53 offen sc1
    s_mov_b32 exec_lo, -1
    s_lshl_b32 s53, s6, 9
    s_add_u32 s53, s53, 786432
    buffer_load_dwordx4 v[132:135], v4, s[8:11], s53 offen
    s_mov_b64 exec, -1
    s_cmp_ge_u32 s50, 43
    s_cbranch_scc1 L_noclr3
    s_lshl_b32 s53, s50, 11
    s_and_b32 s54, s53, 0x1e000
    s_add_u32 s53, s53, s54
    s_add_u32 s53, s53, 917504
    buffer_store_dwordx4 v[20:23], v4, s[8:11], s53 offen sc1
    buffer_store_dwordx4 v[20:23], v4, s[8:11], s53 offen offset:1024 sc1
    s_add_u32 s53, s53, 8192
    buffer_store_dwordx4 v[20:23], v4, s[8:11], s53 offen sc1
    buffer_store_dwordx4 v[20:23], v4, s[8:11], s53 offen offset:1024 sc1
L_noclr3:
    s_waitcnt vmcnt(21)
    v_lshlrev_b32 v96, 16, v16
    v_and_b32 v97, 0xffff0000, v16
    v_lshlrev_b32 v98, 16, v17
    v_and_b32 v99, 0xffff0000, v17
    v_lshlrev_b32 v100, 16, v18
    v_and_b32 v101, 0xffff0000, v18
    v_lshlrev_b32 v102, 16, v19
    v_and_b32 v103, 0xffff0000, v19
    v_add_f32 v24, v96, v97
    v_add_f32 v24, v24, v98
    v_add_f32 v24, v24, v99
    v_add_f32 v24, v24, v100
    v_add_f32 v24, v24, v101
    v_add_f32 v24, v24, v102
    v_add_f32 v24, v24, v103
    s_nop 1
    v_add_f32_dpp v24, v24, v24 row_ror:8 row_mask:0xf bank_mask:0xf
    s_nop 1
    v_add_f32_dpp v24, v24, v24 row_ror:4 row_mask:0xf bank_mask:0xf
    s_nop 1
    v_add_f32_dpp v24, v24, v24 row_ror:2 row_mask:0xf bank_mask:0xf
    s_nop 1
    v_add_f32_dpp v24, v24, v24 row_ror:1 row_mask:0xf bank_mask:0xf
    v_mov_b32 v25, v24
    s_nop 1
    v_permlane16_swap_b32 v24, v25
    v_add_f32 v24, v24, v25
    v_mov_b32 v25, v24
    s_nop 1
    v_permlane32_swap_b32 v24, v25
    v_add_f32 v24, v24, v25
    v_mul_f32 v24, 0x3b000000, v24
    v_sub_f32 v96, v96, v24
    v_sub_f32 v97, v97, v24
    v_sub_f32 v98, v98, v24
    v_sub_f32 v99, v99, v24
    v_sub_f32 v100, v100, v24
    v_sub_f32 v101, v101, v24
    v_sub_f32 v102, v102, v24
    v_sub_f32 v103, v103, v24
    v_mul_f32 v26, v96, v96
    v_fmac_f32 v26, v97, v97
    v_fmac_f32 v26, v98, v98
    v_fmac_f32 v26, v99, v99
    v_fmac_f32 v26, v100, v100
    v_fmac_f32 v26, v101, v101
    v_fmac_f32 v26, v102, v102
    v_fmac_f32 v26, v103, v103
    s_nop 1
    v_add_f32_dpp v26, v26, v26 row_ror:8 row_mask:0xf bank_mask:0xf
    s_nop 1
    v_add_f32_dpp v26, v26, v26 row_ror:4 row_mask:0xf bank_mask:0xf
    s_nop 1
    v_add_f32_dpp v26, v26, v26 row_ror:2 row_mask:0xf bank_mask:0xf
    s_nop 1
    v_add_f32_dpp v26, v26, v26 row_ror:1 row_mask:0xf bank_mask:0xf
    v_mov_b32 v25, v26
    s_nop 1
    v_permlane16_swap_b32 v26, v25
    v_add_f32 v26, v26, v25
    v_mov_b32 v25, v26
    s_nop 1
    v_permlane32_swap_b32 v26, v25
    v_add_f32 v26, v26, v25
    v_mul_f32 v26, 0x3b000000, v26
    v_cvt_pk_bf16_f32 v25, v24, v26
    v_lshlrev_b32 v24, 16, v25
    v_and_b32 v26, 0xffff0000, v25
    v_add_f32 v26, 0x3727c5ac, v26
    v_cvt_pk_bf16_f32 v26, v26, v26
    v_lshlrev_b32 v26, 16, v26
    v_sqrt_f32 v26, v26
    s_nop 0
    v_cvt_pk_bf16_f32 v26, v26, v26
    v_lshlrev_b32 v26, 16, v26
    v_rcp_f32 v26, v26
    v_lshlrev_b32 v14, 16, v14
    v_sub_f32 v14, v14, v24
    v_cvt_pk_bf16_f32 v14, v14, v14
    v_lshlrev_b32 v14, 16, v14
    v_mul_f32 v14, v14, v26
    v_cvt_pk_bf16_f32 v14, v14, v14
    v_lshlrev_b32 v14, 16, v14
    s_waitcnt lgkmcnt(0)
    s_mul_i32 s46, s46, 0x9e3779b1
    s_add_u32 s46, s46, 0x7f4a7c15
    s_min_u32 s46, s46, -2
    s_getreg_b32 s26, hwreg(HW_REG_XCC_ID, 0, 4)
    v_mov_b32 v20, s26
    v_mov_b32 v21, s46
    s_lshl_b32 s53, s6, 3
    s_mov_b64 exec, 1
    buffer_store_dwordx2 v[20:21], v4, s[8:11], s53 offen offset:2048 sc1
    s_mov_b64 exec, -1
    v_and_b32 v7, 7, v1
    v_lshlrev_b32 v7, 3, v7
    s_lshl_b32 s53, s42, 6
    v_add_u32 v7, s53, v7
    s_lshl_b32 s53, s43, 13
    s_add_u32 s53, s53, 65536
    v_add_u32 v6, s53, v4
    s_add_u32 s54, s44, s53
    s_addc_u32 s55, s45, 0
    s_mov_b32 s51, 15
L_spoll_48:
    s_load_dword s60, s[54:55], 60
    s_load_dword s61, s[54:55], 1084
    s_load_dword s62, s[54:55], 2108
    s_load_dword s63, s[54:55], 3132
    s_load_dword s64, s[54:55], 4156
    s_load_dword s65, s[54:55], 5180
    s_load_dword s66, s[54:55], 6204
    s_load_dword s67, s[54:55], 7228
    s_add_u32 s54, s54, 64
    s_addc_u32 s55, s55, 0
    s_waitcnt lgkmcnt(0)
    s_xor_b32 s60, s60, s46
    s_xor_b32 s61, s61, s46
    s_or_b32 s60, s60, s61
    s_xor_b32 s62, s62, s46
    s_or_b32 s60, s60, s62
    s_xor_b32 s63, s63, s46
    s_or_b32 s60, s60, s63
    s_xor_b32 s64, s64, s46
    s_or_b32 s60, s60, s64
    s_xor_b32 s65, s65, s46
    s_or_b32 s60, s60, s65
    s_xor_b32 s66, s66, s46
    s_or_b32 s60, s60, s66
    s_xor_b32 s67, s67, s46
    s_or_b32 s60, s60, s67
    s_cbranch_scc0 L_sok_49
    s_sleep 4
    s_sub_u32 s51, s51, 1
    s_cbranch_scc0 L_spoll_48
L_sok_49:
    v_mov_b32 v15, 272
    ds_write_b32 v15, v15
    s_mov_b32 s51, 2097152
L_poll_50:
    buffer_load_dwordx4 v[96:99], v6, s[8:11], 0 offen offset:0 sc1
    buffer_load_dwordx4 v[100:103], v6, s[8:11], 0 offen offset:1024 sc1
    buffer_load_dwordx4 v[104:107], v6, s[8:11], 0 offen offset:2048 sc1
    buffer_load_dwordx4 v[108:111], v6, s[8:11], 0 offen offset:3072 sc1
    s_mov_b32 s52, 4096
    buffer_load_dwordx4 v[112:115], v6, s[8:11], s52 offen offset:0 sc1
    s_mov_b32 s52, 4096
    buffer_load_dwordx4 v[116:119], v6, s[8:11], s52 offen offset:1024 sc1
    s_mov_b32 s52, 4096
    buffer_load_dwordx4 v[120:123], v6, s[8:11], s52 offen offset:2048 sc1
    s_mov_b32 s52, 4096
    buffer_load_dwordx4 v[124:127], v6, s[8:11], s52 offen offset:3072 sc1
    buffer_load_dwordx2 v[128:129], v7, s[8:11], 0 offen offset:2048 sc1
    s_waitcnt vmcnt(0)
    v_xor_b32 v15, s46, v97
    v_bitop3_b32 v15, v15, v99, s46 bitop3:0xf6
    v_bitop3_b32 v15, v15, v101, s46 bitop3:0xf6
    v_bitop3_b32 v15, v15, v103, s46 bitop3:0xf6
    v_bitop3_b32 v15, v15, v105, s46 bitop3:0xf6
    v_bitop3_b32 v15, v15, v107, s46 bitop3:0xf6
    v_bitop3_b32 v15, v15, v109, s46 bitop3:0xf6
    v_bitop3_b32 v15, v15, v111, s46 bitop3:0xf6
    v_bitop3_b32 v15, v15, v113, s46 bitop3:0xf6
    v_bitop3_b32 v15, v15, v115, s46 bitop3:0xf6
    v_bitop3_b32 v15, v15, v117, s46 bitop3:0xf6
    v_bitop3_b32 v15, v15, v119, s46 bitop3:0xf6
    v_bitop3_b32 v15, v15, v121, s46 bitop3:0xf6
    v_bitop3_b32 v15, v15, v123, s46 bitop3:0xf6
    v_bitop3_b32 v15, v15, v125, s46 bitop3:0xf6
    v_bitop3_b32 v15, v15, v127, s46 bitop3:0xf6
    v_bitop3_b32 v15, v15, v129, s46 bitop3:0xf6
    v_cmp_ne_u32 vcc, 0, v15
    s_cbranch_vccz L_ok_51
    s_sleep 8
    s_sub_u32 s51, s51, 1
    s_cbranch_scc0 L_poll_50
L_ok_51:
    v_add_f32 v24, v96, v100
    v_add_f32 v26, v98, v102
    v_add_f32 v24, v24, v104
    v_add_f32 v26, v26, v106
    v_add_f32 v24, v24, v108
    v_add_f32 v26, v26, v110
    v_add_f32 v24, v24, v112
    v_add_f32 v26, v26, v114
    v_add_f32 v24, v24, v116
    v_add_f32 v26, v26, v118
    v_add_f32 v24, v24, v120
    v_add_f32 v26, v26, v122
    v_add_f32 v24, v24, v124
    v_add_f32 v26, v26, v126
    v_cmp_ne_u32 vcc, s26, v128
    s_nop 0
    s_cmp_eq_u64 vcc, 0
    s_cselect_b32 s26, 2, 1
    v_cvt_pk_bf16_f32 v15, v24, v26
    v_lshlrev_b32 v24, 16, v15
    v_and_b32 v26, 0xffff0000, v15
    v_add_f32 v26, 1.0, v26
    v_cvt_pk_bf16_f32 v26, v26, v26
    v_lshlrev_b32 v26, 16, v26
    v_mul_f32 v14, v14, v26
    v_cvt_pk_bf16_f32 v14, v14, v14
    v_lshlrev_b32 v14, 16, v14
    v_add_f32 v14, v14, v24
    v_cvt_pk_bf16_f32 v14, v14, v14
    s_nop 1
    v_and_b32_dpp v16, v14, v8 row_newbcast:0 row_mask:0xf bank_mask:0xf
    v_and_b32_dpp v17, v14, v9 row_newbcast:0 row_mask:0xf bank_mask:0xf
    v_and_b32_dpp v18, v14, v10 row_newbcast:0 row_mask:0xf bank_mask:0xf
    v_and_b32_dpp v19, v14, v11 row_newbcast:0 row_mask:0xf bank_mask:0xf
    v_and_b32_dpp v20, v14, v8 row_newbcast:1 row_mask:0xf bank_mask:0xf
    v_and_b32_dpp v21, v14, v9 row_newbcast:1 row_mask:0xf bank_mask:0xf
    v_and_b32_dpp v22, v14, v10 row_newbcast:1 row_mask:0xf bank_mask:0xf
    v_and_b32_dpp v23, v14, v11 row_newbcast:1 row_mask:0xf bank_mask:0xf
    v_mfma_f32_16x16x32_bf16 v[28:31], v[32:35], v[16:19], 0
    v_and_b32_dpp v16, v14, v8 row_newbcast:2 row_mask:0xf bank_mask:0xf
    v_and_b32_dpp v17, v14, v9 row_newbcast:2 row_mask:0xf bank_mask:0xf
    v_and_b32_dpp v18, v14, v10 row_newbcast:2 row_mask:0xf bank_mask:0xf
    v_and_b32_dpp v19, v14, v11 row_newbcast:2 row_mask:0xf bank_mask:0xf
    v_mfma_f32_16x16x32_bf16 v[28:31], v[36:39], v[20:23], v[28:31]
    v_and_b32_dpp v20, v14, v8 row_newbcast:3 row_mask:0xf bank_mask:0xf
    v_and_b32_dpp v21, v14, v9 row_newbcast:3 row_mask:0xf bank_mask:0xf
    v_and_b32_dpp v22, v14, v10 row_newbcast:3 row_mask:0xf bank_mask:0xf
    v_and_b32_dpp v23, v14, v11 row_newbcast:3 row_mask:0xf bank_mask:0xf
    v_mfma_f32_16x16x32_bf16 v[28:31], v[40:43], v[16:19], v[28:31]
    v_and_b32_dpp v16, v14, v8 row_newbcast:4 row_mask:0xf bank_mask:0xf
    v_and_b32_dpp v17, v14, v9 row_newbcast:4 row_mask:0xf bank_mask:0xf
    v_and_b32_dpp v18, v14, v10 row_newbcast:4 row_mask:0xf bank_mask:0xf
    v_and_b32_dpp v19, v14, v11 row_newbcast:4 row_mask:0xf bank_mask:0xf
    v_mfma_f32_16x16x32_bf16 v[28:31], v[44:47], v[20:23], v[28:31]
    v_and_b32_dpp v20, v14, v8 row_newbcast:5 row_mask:0xf bank_mask:0xf
    v_and_b32_dpp v21, v14, v9 row_newbcast:5 row_mask:0xf bank_mask:0xf
    v_and_b32_dpp v22, v14, v10 row_newbcast:5 row_mask:0xf bank_mask:0xf
    v_and_b32_dpp v23, v14, v11 row_newbcast:5 row_mask:0xf bank_mask:0xf
    v_mfma_f32_16x16x32_bf16 v[28:31], v[48:51], v[16:19], v[28:31]
    v_and_b32_dpp v16, v14, v8 row_newbcast:6 row_mask:0xf bank_mask:0xf
    v_and_b32_dpp v17, v14, v9 row_newbcast:6 row_mask:0xf bank_mask:0xf
    v_and_b32_dpp v18, v14, v10 row_newbcast:6 row_mask:0xf bank_mask:0xf
    v_and_b32_dpp v19, v14, v11 row_newbcast:6 row_mask:0xf bank_mask:0xf
    v_mfma_f32_16x16x32_bf16 v[28:31], v[52:55], v[20:23], v[28:31]
    v_and_b32_dpp v20, v14, v8 row_newbcast:7 row_mask:0xf bank_mask:0xf
    v_and_b32_dpp v21, v14, v9 row_newbcast:7 row_mask:0xf bank_mask:0xf
    v_and_b32_dpp v22, v14, v10 row_newbcast:7 row_mask:0xf bank_mask:0xf
    v_and_b32_dpp v23, v14, v11 row_newbcast:7 row_mask:0xf bank_mask:0xf
    v_mfma_f32_16x16x32_bf16 v[28:31], v[56:59], v[16:19], v[28:31]
    v_and_b32_dpp v16, v14, v8 row_newbcast:8 row_mask:0xf bank_mask:0xf
    v_and_b32_dpp v17, v14, v9 row_newbcast:8 row_mask:0xf bank_mask:0xf
    v_and_b32_dpp v18, v14, v10 row_newbcast:8 row_mask:0xf bank_mask:0xf
    v_and_b32_dpp v19, v14, v11 row_newbcast:8 row_mask:0xf bank_mask:0xf
    v_mfma_f32_16x16x32_bf16 v[28:31], v[60:63], v[20:23], v[28:31]
    v_and_b32_dpp v20, v14, v8 row_newbcast:9 row_mask:0xf bank_mask:0xf
    v_and_b32_dpp v21, v14, v9 row_newbcast:9 row_mask:0xf bank_mask:0xf
    v_and_b32_dpp v22, v14, v10 row_newbcast:9 row_mask:0xf bank_mask:0xf
    v_and_b32_dpp v23, v14, v11 row_newbcast:9 row_mask:0xf bank_mask:0xf
    v_mfma_f32_16x16x32_bf16 v[28:31], v[64:67], v[16:19], v[28:31]
    v_and_b32_dpp v16, v14, v8 row_newbcast:10 row_mask:0xf bank_mask:0xf
    v_and_b32_dpp v17, v14, v9 row_newbcast:10 row_mask:0xf bank_mask:0xf
    v_and_b32_dpp v18, v14, v10 row_newbcast:10 row_mask:0xf bank_mask:0xf
    v_and_b32_dpp v19, v14, v11 row_newbcast:10 row_mask:0xf bank_mask:0xf
    v_mfma_f32_16x16x32_bf16 v[28:31], v[68:71], v[20:23], v[28:31]
    v_and_b32_dpp v20, v14, v8 row_newbcast:11 row_mask:0xf bank_mask:0xf
    v_and_b32_dpp v21, v14, v9 row_newbcast:11 row_mask:0xf bank_mask:0xf
    v_and_b32_dpp v22, v14, v10 row_newbcast:11 row_mask:0xf bank_mask:0xf
    v_and_b32_dpp v23, v14, v11 row_newbcast:11 row_mask:0xf bank_mask:0xf
    v_mfma_f32_16x16x32_bf16 v[28:31], v[72:75], v[16:19], v[28:31]
    v_and_b32_dpp v16, v14, v8 row_newbcast:12 row_mask:0xf bank_mask:0xf
    v_and_b32_dpp v17, v14, v9 row_newbcast:12 row_mask:0xf bank_mask:0xf
    v_and_b32_dpp v18, v14, v10 row_newbcast:12 row_mask:0xf bank_mask:0xf
    v_and_b32_dpp v19, v14, v11 row_newbcast:12 row_mask:0xf bank_mask:0xf
    v_mfma_f32_16x16x32_bf16 v[28:31], v[76:79], v[20:23], v[28:31]
    v_and_b32_dpp v20, v14, v8 row_newbcast:13 row_mask:0xf bank_mask:0xf
    v_and_b32_dpp v21, v14, v9 row_newbcast:13 row_mask:0xf bank_mask:0xf
    v_and_b32_dpp v22, v14, v10 row_newbcast:13 row_mask:0xf bank_mask:0xf
    v_and_b32_dpp v23, v14, v11 row_newbcast:13 row_mask:0xf bank_mask:0xf
    v_mfma_f32_16x16x32_bf16 v[28:31], v[80:83], v[16:19], v[28:31]
    v_and_b32_dpp v16, v14, v8 row_newbcast:14 row_mask:0xf bank_mask:0xf
    v_and_b32_dpp v17, v14, v9 row_newbcast:14 row_mask:0xf bank_mask:0xf
    v_and_b32_dpp v18, v14, v10 row_newbcast:14 row_mask:0xf bank_mask:0xf
    v_and_b32_dpp v19, v14, v11 row_newbcast:14 row_mask:0xf bank_mask:0xf
    v_mfma_f32_16x16x32_bf16 v[28:31], v[84:87], v[20:23], v[28:31]
    v_and_b32_dpp v20, v14, v8 row_newbcast:15 row_mask:0xf bank_mask:0xf
    v_and_b32_dpp v21, v14, v9 row_newbcast:15 row_mask:0xf bank_mask:0xf
    v_and_b32_dpp v22, v14, v10 row_newbcast:15 row_mask:0xf bank_mask:0xf
    v_and_b32_dpp v23, v14, v11 row_newbcast:15 row_mask:0xf bank_mask:0xf
    v_mfma_f32_16x16x32_bf16 v[28:31], v[88:91], v[16:19], v[28:31]
    s_nop 0
    v_mfma_f32_16x16x32_bf16 v[28:31], v[92:95], v[20:23], v[28:31]
    s_mov_b32 s4, 0xff00ff00
    s_mov_b32 s5, 0xff00ff00
    s_lshl_b32 s53, s6, 10
    s_add_u32 s53, s53, 262144
    s_nop 3
    v_cndmask_b32 v16, v28, v30, s[4:5]
    v_cndmask_b32 v18, v29, v31, s[4:5]
    v_mov_b32 v17, s46
    v_mov_b32 v19, s46
    s_cmp_eq_u32 s26, 2
    s_cbranch_scc0 L_ls_52
    buffer_store_dwordx4 v[16:19], v4, s[8:11], s53 offen
    s_branch L_ld_53
L_ls_52:
    buffer_store_dwordx4 v[16:19], v4, s[8:11], s53 offen sc1
L_ld_53:
    s_lshl_b32 s53, s2, 2
    s_mov_b64 exec, 1
    buffer_store_dword v17, v4, s[8:11], s53 offen offset:1024 sc1
    s_mov_b64 exec, -1
    s_lshl_b32 s53, s42, 13
    s_add_u32 s53, s53, 262144
    v_add_u32 v6, s53, v4
    s_waitcnt vmcnt(1)
    s_add_u32 s54, s44, s53
    s_addc_u32 s55, s45, 0
    s_mov_b32 s51, 15
L_spoll_54:
    s_load_dword s60, s[54:55], 60
    s_load_dword s61, s[54:55], 1084
    s_load_dword s62, s[54:55], 2108
    s_load_dword s63, s[54:55], 3132
    s_load_dword s64, s[54:55], 4156
    s_load_dword s65, s[54:55], 5180
    s_load_dword s66, s[54:55], 6204
    s_load_dword s67, s[54:55], 7228
    s_add_u32 s54, s54, 64
    s_addc_u32 s55, s55, 0
    s_waitcnt lgkmcnt(0)
    s_xor_b32 s60, s60, s46
    s_xor_b32 s61, s61, s46
    s_or_b32 s60, s60, s61
    s_xor_b32 s62, s62, s46
    s_or_b32 s60, s60, s62
    s_xor_b32 s63, s63, s46
    s_or_b32 s60, s60, s63
    s_xor_b32 s64, s64, s46
    s_or_b32 s60, s60, s64
    s_xor_b32 s65, s65, s46
    s_or_b32 s60, s60, s65
    s_xor_b32 s66, s66, s46
    s_or_b32 s60, s60, s66
    s_xor_b32 s67, s67, s46
    s_or_b32 s60, s60, s67
    s_cbranch_scc0 L_sok_55
    s_sleep 4
    s_sub_u32 s51, s51, 1
    s_cbranch_scc0 L_spoll_54
L_sok_55:
    s_mov_b32 s51, 2097152
L_poll_56:
    buffer_load_dwordx4 v[96:99], v6, s[8:11], 0 offen offset:0 sc1
    buffer_load_dwordx4 v[100:103], v6, s[8:11], 0 offen offset:1024 sc1
    buffer_load_dwordx4 v[104:107], v6, s[8:11], 0 offen offset:2048 sc1
    buffer_load_dwordx4 v[108:111], v6, s[8:11], 0 offen offset:3072 sc1
    s_mov_b32 s52, 4096
    buffer_load_dwordx4 v[112:115], v6, s[8:11], s52 offen offset:0 sc1
    s_mov_b32 s52, 4096
    buffer_load_dwordx4 v[116:119], v6, s[8:11], s52 offen offset:1024 sc1
    s_mov_b32 s52, 4096
    buffer_load_dwordx4 v[120:123], v6, s[8:11], s52 offen offset:2048 sc1
    s_mov_b32 s52, 4096
    buffer_load_dwordx4 v[124:127], v6, s[8:11], s52 offen offset:3072 sc1
    s_waitcnt vmcnt(0)
    v_xor_b32 v15, s46, v97
    v_bitop3_b32 v15, v15, v99, s46 bitop3:0xf6
    v_bitop3_b32 v15, v15, v101, s46 bitop3:0xf6
    v_bitop3_b32 v15, v15, v103, s46 bitop3:0xf6
    v_bitop3_b32 v15, v15, v105, s46 bitop3:0xf6
    v_bitop3_b32 v15, v15, v107, s46 bitop3:0xf6
    v_bitop3_b32 v15, v15, v109, s46 bitop3:0xf6
    v_bitop3_b32 v15, v15, v111, s46 bitop3:0xf6
    v_bitop3_b32 v15, v15, v113, s46 bitop3:0xf6
    v_bitop3_b32 v15, v15, v115, s46 bitop3:0xf6
    v_bitop3_b32 v15, v15, v117, s46 bitop3:0xf6
    v_bitop3_b32 v15, v15, v119, s46 bitop3:0xf6
    v_bitop3_b32 v15, v15, v121, s46 bitop3:0xf6
    v_bitop3_b32 v15, v15, v123, s46 bitop3:0xf6
    v_bitop3_b32 v15, v15, v125, s46 bitop3:0xf6
    v_bitop3_b32 v15, v15, v127, s46 bitop3:0xf6
    v_cmp_ne_u32 vcc, 0, v15
    s_cbranch_vccz L_ok_57
    s_sleep 8
    s_sub_u32 s51, s51, 1
    s_cbranch_scc0 L_poll_56
L_ok_57:
    v_add_f32 v24, v96, v100
    v_add_f32 v26, v98, v102
    v_add_f32 v24, v24, v104
    v_add_f32 v26, v26, v106
    v_add_f32 v24, v24, v108
    v_add_f32 v26, v26, v110
    v_add_f32 v24, v24, v112
    v_add_f32 v26, v26, v114
    v_add_f32 v24, v24, v116
    v_add_f32 v26, v26, v118
    v_add_f32 v24, v24, v120
    v_add_f32 v26, v26, v122
    v_add_f32 v24, v24, v124
    v_add_f32 v26, v26, v126
    v_cvt_pk_bf16_f32 v24, v24, v26
    v_lshrrev_b32 v12, 3, v1
    v_lshlrev_b32 v12, 4, v12
    v_and_b32 v13, 7, v1
    v_add_lshl_u32 v12, v12, v13, 1
    ds_write_b16 v12, v24 offset:0
    ds_write_b16_d16_hi v12, v24 offset:16
    v_mov_b32 v13, 256
    v_mov_b32 v12, s26
    s_waitcnt lgkmcnt(0)
    ds_write_b32 v13, v12
L_prep:
    s_cmp_eq_u32 s58, s49
    s_cselect_b32 s57, 1, 0
    s_cmp_lt_u32 s50, 43
    s_cselect_b32 s57, 1, s57
    s_cmp_eq_u32 s57, 0
    s_cbranch_scc1 L_prep_done
    s_lshl_b32 s52, s49, 7
    v_lshl_add_u32 v7, v2, 5, s52
    v_and_b32 v5, 3, v1
    v_lshl_add_u32 v7, v5, 3, v7
    v_bfe_u32 v5, v1, 3, 1
    v_lshl_add_u32 v7, v5, 2, v7
    v_bfe_u32 v5, v1, 2, 1
    v_add_u32 v7, v7, v5
    v_lshlrev_b32 v5, 1, v7
    s_waitcnt vmcnt(0)
    global_load_ushort v158, v5, s[16:17]
    global_load_ushort v159, v5, s[16:17] offset:4
    s_min_u32 s52, s50, 42
    s_lshl_b32 s52, s52, 5
    v_and_b32 v5, 7, v3
    v_lshlrev_b32 v5, 2, v5
    v_add3_u32 v5, v5, v2, s52
    v_lshlrev_b32 v5, 1, v5
    global_load_ushort v160, v5, s[30:31]
    v_lshlrev_b32 v7, 2, v7
    v_and_b32 v152, 0x3f803f80, v8
    v_and_b32 v153, 0x3f803f80, v9
    v_and_b32 v154, 0x3f803f80, v10
    v_and_b32 v155, 0x3f803f80, v11
    v_lshlrev_b32 v156, 10, v2
    v_lshl_add_u32 v156, v3, 4, v156
    s_lshl_b32 s52, s49, 8
    s_add_u32 s52, s52, 655360
    v_add_u32 v156, s52, v156
    s_cmp_lt_u32 s50, 43
    s_cbranch_scc1 L_prep_mlp
    v_bfe_u32 v148, v1, 3, 2
    v_lshlrev_b32 v148, 11, v148
    v_lshrrev_b32 v6, 5, v1
    v_lshl_add_u32 v148, v6, 14, v148
    v_and_b32 v6, 7, v1
    v_lshl_add_u32 v148, v6, 4, v148
    s_lshl_b32 s52, s58, 9
    s_bfe_u32 s53, s48, 0x20002
    s_lshl_b32 s53, s53, 7
    s_add_u32 s52, s52, s53
    v_add_u32 v148, s52, v148
    v_lshl_add_u32 v6, v2, 3, v6
    s_lshr_b32 s52, s52, 2
    v_add_u32 v6, s52, v6
    v_lshlrev_b32 v150, 2, v6
    v_lshlrev_b32 v149, 1, v6
    global_load_ushort v151, v149, s[34:35]
    s_branch L_prep_done
L_prep_mlp:
    s_mov_b32 s20, s32
    s_mov_b32 s21, s33
    s_mov_b32 s22, 1409024
    s_mov_b32 s23, 0x20000
    s_lshl_b32 s52, s50, 5
    v_add_u32 v0, s52, v2
    v_lshlrev_b32 v0, 10, v0
    v_lshlrev_b32 v6, 4, v3
    s_lshl_b32 s53, s49, 8
    v_add3_u32 v0, v0, v6, s53
    v_lshlrev_b32 v157, 5, v2
    v_bfe_u32 v6, v3, 3, 1
    v_lshl_add_u32 v157, v6, 3, v157
    v_bfe_u32 v6, v3, 2, 1
    v_lshl_add_u32 v157, v6, 1, v157
    v_lshlrev_b32 v157, 6, v157
    v_and_b32 v6, 3, v3
    v_lshl_add_u32 v157, v6, 3, v157
    s_lshl_b32 s54, s49, 13
    s_add_u32 s54, s54, 16384
    v_add_u32 v157, s54, v157
    s_lshl_b32 s52, s49, 3
    s_add_u32 s52, s52, 12288
    v_mov_b32 v148, s52
    v_mov_b32 v149, 7168
    v_cmp_eq_u32 vcc, 3, v2
    s_nop 1
    v_cndmask_b32 v148, v149, v148, vcc
    s_lshl_b32 s52, s49, 2
    v_lshl_add_u32 v149, v1, 4, s52
    v_and_b32 v150, 7, v3
    v_lshl_add_u32 v150, v150, 2, v2
    v_lshlrev_b32 v150, 4, v150
    v_and_b32 v151, 7, v3
    v_lshl_add_u32 v151, v2, 3, v151
    v_lshlrev_b32 v151, 4, v151
    v_lshrrev_b32 v6, 3, v3
    v_lshl_add_u32 v151, v6, 13, v151
    s_lshl_b32 s53, s50, 11
    s_and_b32 s54, s53, 0x1e000
    s_add_u32 s53, s53, s54
    s_lshl_b32 s52, s49, 9
    s_add_u32 s53, s53, s52
    s_add_u32 s53, s53, 917504
    v_add_u32 v151, s53, v151
    v_mov_b32 v161, 0
L_prep_done:
    v_and_b32 v14, 7, v1
    v_lshrrev_b32 v15, 3, v1
    s_lshl_b32 s52, s49, 7
    v_lshl_add_u32 v24, v14, 4, s52
    v_lshl_add_u32 v24, v15, 9, v24
    v_lshlrev_b32 v25, 2, v15
    v_lshlrev_b32 v27, 4, v14
    v_lshl_add_u32 v27, v2, 2, v27
    s_lshl_b32 s55, s6, 9
    s_add_u32 s55, s55, s52
    s_add_u32 s55, s55, 524288
    s_lshl_b32 s54, s42, 12
    s_add_u32 s54, s54, 524288
    v_add_u32 v12, s54, v24
    v_cmp_ne_u32 s[4:5], s43, v15
    v_lshl_add_u32 v14, v2, 3, v14
    v_lshlrev_b32 v14, 4, v14
    s_lshl_b32 s52, s49, 9
    v_add_u32 v14, s52, v14
    v_lshlrev_b32 v15, 3, v1
    v_mov_b32 v144, 0
    v_mov_b32 v145, 0
    v_mov_b32 v146, 0
    v_mov_b32 v147, 0
    s_mov_b32 s12, s24
    s_mov_b32 s13, s25
    s_mov_b32 s14, 4194304
    s_mov_b32 s15, 0x20000
    s_lshl_b32 s52, s42, 7
    s_lshl_b32 s53, s49, 5
    s_add_u32 s52, s52, s53
    v_lshl_add_u32 v5, v2, 3, s52
    v_lshlrev_b32 v5, 10, v5
    v_lshlrev_b32 v6, 4, v3
    s_and_b32 s53, s43, 3
    s_lshl_b32 s53, s53, 8
    v_add3_u32 v5, v5, v6, s53
    s_and_b32 s7, s7, 0xfffffc00
    s_add_u32 s7, s7, s53
    s_lshl_b32 s53, s49, 13
    s_add_u32 s7, s7, s53
    s_waitcnt vmcnt(0)
    s_cmp_eq_u32 s49, 3
    s_cbranch_scc0 L_noxm
    v_mov_b32 v16, 264
    s_mov_b32 s51, 16777216
L_lw_58:
    ds_read_b32 v17, v16
    s_waitcnt lgkmcnt(0)
    v_cmp_gt_u32 vcc, 8, v17
    s_cbranch_vccz L_lok_59
    s_sleep 2
    s_sub_u32 s51, s51, 1
    s_cbranch_scc0 L_lw_58
L_lok_59:
    v_and_b32 v13, 7, v1
    v_lshlrev_b32 v13, 3, v13
    ds_read_b64 v[20:21], v13 offset:512
    v_mov_b32 v16, 256
    ds_read_b32 v17, v16
    s_lshl_b32 s53, s42, 12
    s_add_u32 s53, s53, 786432
    s_lshl_b32 s56, s43, 3
    s_add_u32 s56, s56, s53
    s_lshl_b32 s53, s6, 9
    s_add_u32 s53, s53, 786432
    v_lshlrev_b32 v22, 6, v1
    s_waitcnt lgkmcnt(0)
    v_readfirstlane_b32 s26, v17
    v_mul_f32 v20, 0x3fb8aa3b, v20
    v_mov_b32 v16, v20
    s_nop 1
    v_max_f32_dpp v16, v16, v16 quad_perm:[1,0,3,2] row_mask:0xf bank_mask:0xf
    s_nop 1
    v_max_f32_dpp v16, v16, v16 quad_perm:[2,3,0,1] row_mask:0xf bank_mask:0xf
    s_nop 1
    v_max_f32_dpp v16, v16, v16 row_half_mirror row_mask:0xf bank_mask:0xf
    v_sub_f32 v18, v20, v16
    v_exp_f32 v18, v18
    s_nop 0
    v_mul_f32 v18, v21, v18
    s_nop 1
    v_add_f32_dpp v18, v18, v18 quad_perm:[1,0,3,2] row_mask:0xf bank_mask:0xf
    s_nop 1
    v_add_f32_dpp v18, v18, v18 quad_perm:[2,3,0,1] row_mask:0xf bank_mask:0xf
    s_nop 1
    v_add_f32_dpp v18, v18, v18 row_half_mirror row_mask:0xf bank_mask:0xf
    v_log_f32 v18, v18
    v_mov_b32 v19, s46
    v_add_f32 v18, v18, v16
    s_cmp_eq_u32 s26, 2
    s_cbranch_scc0 L_ls_60
    buffer_store_dwordx2 v[18:19], v22, s[8:11], s56 offen
    s_branch L_ld_61
L_ls_60:
    buffer_store_dwordx2 v[18:19], v22, s[8:11], s56 offen sc1
L_ld_61:
    v_add_u32 v13, s53, v13
    s_add_u32 s56, s44, s53
    s_addc_u32 s53, s45, 0
    s_mov_b32 s52, s56
    s_mov_b32 s51, 7
    s_waitcnt vmcnt(0)
L_xmp:
    s_load_dwordx16 s[60:75], s[52:53], 0
    s_add_u32 s52, s52, 64
    s_addc_u32 s53, s53, 0
    s_waitcnt lgkmcnt(0)
    s_xor_b32 s56, s61, s46
    s_xor_b32 s63, s63, s46
    s_or_b32 s56, s56, s63
    s_xor_b32 s65, s65, s46
    s_or_b32 s56, s56, s65
    s_xor_b32 s67, s67, s46
    s_or_b32 s56, s56, s67
    s_xor_b32 s69, s69, s46
    s_or_b32 s56, s56, s69
    s_xor_b32 s71, s71, s46
    s_or_b32 s56, s56, s71
    s_xor_b32 s73, s73, s46
    s_or_b32 s56, s56, s73
    s_xor_b32 s75, s75, s46
    s_or_b32 s56, s56, s75
    s_cbranch_scc0 L_xmok
    s_sleep 8
    s_sub_u32 s51, s51, 1
    s_cbranch_scc0 L_xmp
    s_mov_b32 s51, 2097152
L_poll_62:
    buffer_load_dwordx2 v[22:23], v13, s[8:11], 0 offen sc1
    s_waitcnt vmcnt(0)
    v_xor_b32 v16, s46, v23
    v_cmp_ne_u32 vcc, 0, v16
    s_cbranch_vccz L_ok_63
    s_sleep 6
    s_sub_u32 s51, s51, 1
    s_cbranch_scc0 L_poll_62
L_ok_63:
    s_branch L_xmv
L_xmok:
    v_writelane_b32 v22, s60, 0
    v_writelane_b32 v22, s62, 1
    v_writelane_b32 v22, s64, 2
    v_writelane_b32 v22, s66, 3
    v_writelane_b32 v22, s68, 4
    v_writelane_b32 v22, s70, 5
    v_writelane_b32 v22, s72, 6
    v_writelane_b32 v22, s74, 7
L_xmv:
    s_nop 1
    v_mov_b32 v16, v22
    s_nop 1
    v_max_f32_dpp v16, v16, v16 quad_perm:[1,0,3,2] row_mask:0xf bank_mask:0xf
    s_nop 1
    v_max_f32_dpp v16, v16, v16 quad_perm:[2,3,0,1] row_mask:0xf bank_mask:0xf
    s_nop 1
    v_max_f32_dpp v16, v16, v16 row_half_mirror row_mask:0xf bank_mask:0xf
    v_sub_f32 v22, v22, v16
    v_sub_f32 v20, v20, v16
    v_exp_f32 v22, v22
    v_exp_f32 v20, v20
    s_nop 0
    v_add_f32_dpp v22, v22, v22 quad_perm:[1,0,3,2] row_mask:0xf bank_mask:0xf
    s_nop 1
    v_add_f32_dpp v22, v22, v22 quad_perm:[2,3,0,1] row_mask:0xf bank_mask:0xf
    s_nop 1
    v_add_f32_dpp v22, v22, v22 row_half_mirror row_mask:0xf bank_mask:0xf
    v_rcp_f32 v22, v22
    v_lshlrev_b32 v13, 2, v1
    v_mul_f32 v20, v20, v22
    s_mov_b64 exec, 0xff
    ds_write_b32 v13, v20 offset:640
    s_mov_b64 exec, -1
L_noxm:
    s_cmp_lt_u32 s43, 4
    s_cbranch_scc1 L_nowo
    v_mov_b32 v16, 260
    s_mov_b32 s51, 16777216
L_lw_64:
    ds_read_b32 v17, v16
    s_waitcnt lgkmcnt(0)
    v_cmp_gt_u32 vcc, 8, v17
    s_cbranch_vccz L_lok_65
    s_sleep 2
    s_sub_u32 s51, s51, 1
    s_cbranch_scc0 L_lw_64
L_lok_65:
    buffer_load_dwordx4 v[32:35], v5, s[12:15], 0 offen offset:0 nt
    buffer_load_dwordx4 v[36:39], v5, s[12:15], 0 offen offset:1024 nt
    buffer_load_dwordx4 v[40:43], v5, s[12:15], 0 offen offset:2048 nt
    buffer_load_dwordx4 v[44:47], v5, s[12:15], 0 offen offset:3072 nt
    s_mov_b32 s52, 4096
    buffer_load_dwordx4 v[48:51], v5, s[12:15], s52 offen offset:0 nt
    s_mov_b32 s52, 4096
    buffer_load_dwordx4 v[52:55], v5, s[12:15], s52 offen offset:1024 nt
    s_mov_b32 s52, 4096
    buffer_load_dwordx4 v[56:59], v5, s[12:15], s52 offen offset:2048 nt
    s_mov_b32 s52, 4096
    buffer_load_dwordx4 v[60:63], v5, s[12:15], s52 offen offset:3072 nt
L_nowo:
    s_mov_b32 s12, s28
    s_mov_b32 s13, s29
    s_mov_b32 s14, 1409024
    s_mov_b32 s15, 0x20000
    s_lshl_b32 s52, s49, 7
    v_lshrrev_b32 v5, 2, v1
    v_add_u32 v5, s52, v5
    v_mul_u32_u24 v5, 2752, v5
    v_and_b32 v6, 3, v1
    v_lshlrev_b32 v6, 4, v6
    s_lshl_b32 s53, s50, 6
    v_add3_u32 v5, v5, v6, s53
    s_lshl_b32 s54, s49, 13
    s_add_u32 s54, s54, 16384
    v_mov_b32 v16, 256
    s_mov_b32 s51, 16777216
L_lw_66:
    ds_read_b32 v17, v16
    s_waitcnt lgkmcnt(0)
    v_cmp_gt_u32 vcc, 1, v17
    s_cbranch_vccz L_lok_67
    s_sleep 2
    s_sub_u32 s51, s51, 1
    s_cbranch_scc0 L_lw_66
L_lok_67:
    v_readfirstlane_b32 s26, v17
    s_cmp_eq_u32 s57, 0
    s_cbranch_scc1 L_nopar
    v_mov_b32 v16, 268
    s_mov_b32 s51, 16777216
L_lw_68:
    ds_read_b32 v17, v16
    s_waitcnt lgkmcnt(0)
    v_cmp_gt_u32 vcc, 1, v17
    s_cbranch_vccz L_lok_69
    s_sleep 2
    s_sub_u32 s51, s51, 1
    s_cbranch_scc0 L_lw_68
L_lok_69:
    v_and_b32 v17, 0x2000, v17
    v_add_u32 v156, v156, v17
L_nopar:
    v_lshlrev_b32 v6, 2, v1
    s_mov_b32 s51, 2097152
    s_cmp_lt_u32 s43, 4
    s_barrier
    ds_read_b128 v[16:19], v24 offset:1024
    ds_read_b32 v20, v25 offset:640
    s_cbranch_scc1 L_noe1l
    s_mov_b64 exec, s[4:5]
    buffer_load_dwordx4 v[144:147], v12, s[8:11], 0 offen sc1
    s_mov_b64 exec, -1
L_noe1l:
    s_waitcnt lgkmcnt(0)
    v_mul_f32 v16, v16, v20
    v_mul_f32 v17, v17, v20
    v_mul_f32 v18, v18, v20
    v_mul_f32 v19, v19, v20
    s_nop 0
    v_permlane32_swap_b32 v16, v18
    v_permlane32_swap_b32 v17, v19
    v_add_f32 v16, v16, v18
    v_add_f32 v17, v17, v19
    s_nop 1
    v_permlane16_swap_b32 v16, v17
    v_add_f32 v16, v16, v17
    s_nop 1
    v_add_f32_dpp v21, v16, v16 row_ror:8 row_mask:0xf bank_mask:0xf
    s_mov_b32 exec_lo, 0x00ff00ff
    s_mov_b32 exec_hi, 0x00ff00ff
    v_min_u32 v22, -2, v21
    s_cmp_eq_u32 s26, 2
    s_cbranch_scc0 L_ls_70
    buffer_store_dword v22, v27, s[8:11], s55 offen
    s_branch L_ld_71
L_ls_70:
    buffer_store_dword v22, v27, s[8:11], s55 offen sc1
L_ld_71:
    s_mov_b64 exec, -1
    s_cmp_lt_u32 s43, 4
    s_cbranch_scc1 L_side
    s_waitcnt vmcnt(1)
    v_max_u32 v20, v144, v145
    v_max3_u32 v20, v20, v146, v147
    v_cmp_eq_u32 vcc, -1, v20
    s_cbranch_vccz L_e1ok
L_e1poll:
    s_mov_b64 exec, s[4:5]
    buffer_load_dwordx4 v[144:147], v12, s[8:11], 0 offen sc1
    s_mov_b64 exec, -1
    s_sleep 1
    s_waitcnt vmcnt(3)
    v_max_u32 v20, v144, v145
    v_max3_u32 v20, v20, v146, v147
    v_cmp_eq_u32 vcc, -1, v20
    s_cbranch_vccz L_e1ok
    s_sub_u32 s51, s51, 1
    s_cbranch_scc0 L_e1poll
L_e1ok:
    v_mov_b32 v16, v144
    v_mov_b32 v17, v145
    v_mov_b32 v18, v146
    v_mov_b32 v19, v147
    s_nop 0
    v_permlane32_swap_b32 v16, v18
    v_permlane32_swap_b32 v17, v19
    v_add_f32 v16, v16, v18
    v_add_f32 v17, v17, v19
    s_nop 1
    v_permlane16_swap_b32 v16, v17
    v_add_f32 v16, v16, v17
    s_nop 1
    v_add_f32_dpp v16, v16, v16 row_ror:8 row_mask:0xf bank_mask:0xf
    v_add_f32 v16, v16, v21
    v_cvt_pk_bf16_f32 v16, v16, v16
    s_nop 1
    v_and_b32_dpp v20, v16, v8 row_newbcast:0 row_mask:0xf bank_mask:0xf
    v_and_b32_dpp v21, v16, v9 row_newbcast:0 row_mask:0xf bank_mask:0xf
    v_and_b32_dpp v22, v16, v10 row_newbcast:0 row_mask:0xf bank_mask:0xf
    v_and_b32_dpp v23, v16, v11 row_newbcast:0 row_mask:0xf bank_mask:0xf
    v_and_b32_dpp v24, v16, v8 row_newbcast:1 row_mask:0xf bank_mask:0xf
    v_and_b32_dpp v25, v16, v9 row_newbcast:1 row_mask:0xf bank_mask:0xf
    v_and_b32_dpp v26, v16, v10 row_newbcast:1 row_mask:0xf bank_mask:0xf
    v_and_b32_dpp v27, v16, v11 row_newbcast:1 row_mask:0xf bank_mask:0xf
    v_mfma_f32_16x16x32_bf16 v[28:31], v[32:35], v[20:23], 0
    v_and_b32_dpp v20, v16, v8 row_newbcast:2 row_mask:0xf bank_mask:0xf
    v_and_b32_dpp v21, v16, v9 row_newbcast:2 row_mask:0xf bank_mask:0xf
    v_and_b32_dpp v22, v16, v10 row_newbcast:2 row_mask:0xf bank_mask:0xf
    v_and_b32_dpp v23, v16, v11 row_newbcast:2 row_mask:0xf bank_mask:0xf
    v_mfma_f32_16x16x32_bf16 v[28:31], v[36:39], v[24:27], v[28:31]
    v_and_b32_dpp v24, v16, v8 row_newbcast:3 row_mask:0xf bank_mask:0xf
    v_and_b32_dpp v25, v16, v9 row_newbcast:3 row_mask:0xf bank_mask:0xf
    v_and_b32_dpp v26, v16, v10 row_newbcast:3 row_mask:0xf bank_mask:0xf
    v_and_b32_dpp v27, v16, v11 row_newbcast:3 row_mask:0xf bank_mask:0xf
    v_mfma_f32_16x16x32_bf16 v[28:31], v[40:43], v[20:23], v[28:31]
    v_and_b32_dpp v20, v16, v8 row_newbcast:4 row_mask:0xf bank_mask:0xf
    v_and_b32_dpp v21, v16, v9 row_newbcast:4 row_mask:0xf bank_mask:0xf
    v_and_b32_dpp v22, v16, v10 row_newbcast:4 row_mask:0xf bank_mask:0xf
    v_and_b32_dpp v23, v16, v11 row_newbcast:4 row_mask:0xf bank_mask:0xf
    v_mfma_f32_16x16x32_bf16 v[28:31], v[44:47], v[24:27], v[28:31]
    v_and_b32_dpp v24, v16, v8 row_newbcast:5 row_mask:0xf bank_mask:0xf
    v_and_b32_dpp v25, v16, v9 row_newbcast:5 row_mask:0xf bank_mask:0xf
    v_and_b32_dpp v26, v16, v10 row_newbcast:5 row_mask:0xf bank_mask:0xf
    v_and_b32_dpp v27, v16, v11 row_newbcast:5 row_mask:0xf bank_mask:0xf
    v_mfma_f32_16x16x32_bf16 v[28:31], v[48:51], v[20:23], v[28:31]
    v_and_b32_dpp v20, v16, v8 row_newbcast:6 row_mask:0xf bank_mask:0xf
    v_and_b32_dpp v21, v16, v9 row_newbcast:6 row_mask:0xf bank_mask:0xf
    v_and_b32_dpp v22, v16, v10 row_newbcast:6 row_mask:0xf bank_mask:0xf
    v_and_b32_dpp v23, v16, v11 row_newbcast:6 row_mask:0xf bank_mask:0xf
    v_mfma_f32_16x16x32_bf16 v[28:31], v[52:55], v[24:27], v[28:31]
    v_and_b32_dpp v24, v16, v8 row_newbcast:7 row_mask:0xf bank_mask:0xf
    v_and_b32_dpp v25, v16, v9 row_newbcast:7 row_mask:0xf bank_mask:0xf
    v_and_b32_dpp v26, v16, v10 row_newbcast:7 row_mask:0xf bank_mask:0xf
    v_and_b32_dpp v27, v16, v11 row_newbcast:7 row_mask:0xf bank_mask:0xf
    v_mfma_f32_16x16x32_bf16 v[28:31], v[56:59], v[20:23], v[28:31]
    s_nop 0
    v_mfma_f32_16x16x32_bf16 v[28:31], v[60:63], v[24:27], v[28:31]
    s_nop 7
    ds_write_b128 v14, v[28:31] offset:5120
    s_waitcnt lgkmcnt(0)
    s_barrier
    s_cmp_gt_u32 s49, 1
    s_cbranch_scc1 L_noe2
    ds_read_b64 v[16:17], v15 offset:5120
    ds_read_b64 v[18:19], v15 offset:5632
    ds_read_b64 v[20:21], v15 offset:6144
    ds_read_b64 v[22:23], v15 offset:6656
    s_waitcnt lgkmcnt(0)
    v_pk_add_f32 v[16:17], v[16:17], v[18:19]
    v_pk_add_f32 v[20:21], v[20:21], v[22:23]
    v_pk_add_f32 v[16:17], v[16:17], v[20:21]
    v_cvt_pk_bf16_f32 v16, v16, v17
    v_min_u32 v16, -2, v16
    buffer_store_dword v16, v6, s[8:11], s7 offen sc1
L_noe2:
    s_mov_b32 s12, s32
    s_mov_b32 s13, s33
    s_mov_b32 s14, 1409024
    s_mov_b32 s15, 0x20000
    s_sub_u32 s52, s48, 16
    s_lshl_b32 s52, s52, 2
    s_add_u32 s52, s52, s49
    s_mul_i32 s52, s52, 3072
    s_lshl_b32 s53, s27, 15
    s_add_u32 s52, s52, s53
    v_lshl_add_u32 v5, v1, 6, s52
    s_barrier
    s_mov_b32 exec_hi, 0xffff
    buffer_load_dword v100, v5, s[12:15], 0 offen
    s_mov_b64 exec, -1
    s_cmp_eq_u32 s57, 0
    s_cbranch_scc1 L_fin
    s_mov_b32 s51, 2097152
L_side:
    s_cmp_eq_u32 s57, 0
    s_cbranch_scc0 L_x1
    s_cmp_lt_u32 s48, 8
    s_cbranch_scc1 L_fin
    s_sub_u32 s52, s48, 8
    s_lshl_b32 s52, s52, 2
    s_add_u32 s52, s52, s49
    s_lshl_b32 s52, s52, 4
    v_lshrrev_b32 v5, 3, v1
    v_add_u32 v5, s52, v5
    v_mul_u32_u24 v5, 2752, v5
    v_and_b32 v6, 7, v1
    s_cmp_lt_u32 s47, 3
    s_cselect_b32 s53, 5, 4
    v_min_u32 v6, s53, v6
    v_add_lshl_u32 v6, v6, s27, 6
    v_add_u32 v5, v5, v6
    v_add_u32 v6, 8*2752, v5
    buffer_load_dword v18, v5, s[12:15], 0 offen
    buffer_load_dword v19, v6, s[12:15], 0 offen
    s_branch L_fin
L_x1:
    v_lshlrev_b32 v6, 1, v7
    s_cmp_ge_u32 s50, 43
    s_cbranch_scc1 L_modpoll
    s_barrier
    buffer_load_dwordx4 v[88:91], v4, s[8:11], 0 offen offset:1024 sc1
    s_mov_b32 s52, 4096
    buffer_load_dwordx2 v[80:81], v6, s[8:11], s52 offen offset:0 sc1
    s_mov_b32 s52, 4096
    buffer_load_dwordx2 v[82:83], v6, s[8:11], s52 offen offset:16 sc1
    s_mov_b32 s52, 8192
    buffer_load_dwordx2 v[84:85], v6, s[8:11], s52 offen offset:0 sc1
    s_mov_b32 s52, 8192
    buffer_load_dwordx2 v[86:87], v6, s[8:11], s52 offen offset:16 sc1
    s_add_u32 m0, s54, 0
    s_mov_b32 s52, 0
    buffer_load_dwordx4 v5, s[12:15], s52 offen nt lds
    s_add_u32 m0, s54, 1024
    s_mov_b32 s52, 44032
    buffer_load_dwordx4 v5, s[12:15], s52 offen nt lds
    s_add_u32 m0, s54, 2048
    s_mov_b32 s52, 88064
    buffer_load_dwordx4 v5, s[12:15], s52 offen nt lds
    s_add_u32 m0, s54, 3072
    s_mov_b32 s52, 132096
    buffer_load_dwordx4 v5, s[12:15], s52 offen nt lds
    s_add_u32 m0, s54, 4096
    s_mov_b32 s52, 176128
    buffer_load_dwordx4 v5, s[12:15], s52 offen nt lds
    s_add_u32 m0, s54, 5120
    s_mov_b32 s52, 220160
    buffer_load_dwordx4 v5, s[12:15], s52 offen nt lds
    s_add_u32 m0, s54, 6144
    s_mov_b32 s52, 264192
    buffer_load_dwordx4 v5, s[12:15], s52 offen nt lds
    s_add_u32 m0, s54, 7168
    s_mov_b32 s52, 308224
    buffer_load_dwordx4 v5, s[12:15], s52 offen nt lds
    s_waitcnt vmcnt(8)
    s_branch L_modchk
L_modpoll:
    buffer_load_dwordx4 v[88:91], v4, s[8:11], 0 offen offset:1024 sc1
    s_mov_b32 s52, 4096
    buffer_load_dwordx2 v[80:81], v6, s[8:11], s52 offen offset:0 sc1
    s_mov_b32 s52, 4096
    buffer_load_dwordx2 v[82:83], v6, s[8:11], s52 offen offset:16 sc1
    s_mov_b32 s52, 8192
    buffer_load_dwordx2 v[84:85], v6, s[8:11], s52 offen offset:0 sc1
    s_mov_b32 s52, 8192
    buffer_load_dwordx2 v[86:87], v6, s[8:11], s52 offen offset:16 sc1
    s_waitcnt vmcnt(0)
L_modchk:
    v_xor_b32 v15, s46, v81
    v_bitop3_b32 v15, v15, v83, s46 bitop3:0xf6
    v_bitop3_b32 v15, v15, v85, s46 bitop3:0xf6
    v_bitop3_b32 v15, v15, v87, s46 bitop3:0xf6
    v_bitop3_b32 v15, v15, v88, s46 bitop3:0xf6
    v_bitop3_b32 v15, v15, v89, s46 bitop3:0xf6
    v_bitop3_b32 v15, v15, v90, s46 bitop3:0xf6
    v_bitop3_b32 v15, v15, v91, s46 bitop3:0xf6
    v_cmp_ne_u32 vcc, 0, v15
    s_cbranch_vccz L_modok
    s_sub_u32 s51, s51, 1
    s_cbranch_scc0 L_modpoll
L_modok:
    buffer_load_dwordx4 v[112:115], v156, s[8:11], 0 offen offset:0 sc1
    s_mov_b32 s52, 4096
    buffer_load_dwordx4 v[116:119], v156, s[8:11], s52 offen offset:0 sc1
    s_mov_b32 s52, 16384
    buffer_load_dwordx4 v[120:123], v156, s[8:11], s52 offen offset:0 sc1
    s_mov_b32 s52, 20480
    buffer_load_dwordx4 v[124:127], v156, s[8:11], s52 offen offset:0 sc1
    s_mov_b32 s52, 32768
    buffer_load_dwordx4 v[128:131], v156, s[8:11], s52 offen offset:0 sc1
    s_mov_b32 s52, 36864
    buffer_load_dwordx4 v[132:135], v156, s[8:11], s52 offen offset:0 sc1
    s_mov_b32 s52, 49152
    buffer_load_dwordx4 v[136:139], v156, s[8:11], s52 offen offset:0 sc1
    s_mov_b32 s52, 53248
    buffer_load_dwordx4 v[140:143], v156, s[8:11], s52 offen offset:0 sc1
    v_lshlrev_b32 v162, 16, v80
    v_lshlrev_b32 v163, 16, v82
    v_and_b32 v164, 0xffff0000, v80
    v_and_b32 v165, 0xffff0000, v82
    v_lshlrev_b32 v166, 16, v84
    v_lshlrev_b32 v167, 16, v86
    v_and_b32 v16, 0xffff0000, v84
    v_and_b32 v17, 0xffff0000, v86
    v_add_f32 v164, 1.0, v164
    v_add_f32 v165, 1.0, v165
    ds_write_b32 v7, v16 offset:10240
    ds_write_b32 v7, v17 offset:10248
    v_lshlrev_b32 v158, 16, v158
    v_lshlrev_b32 v159, 16, v159
    v_lshlrev_b32 v160, 16, v160
    v_cvt_pk_bf16_f32 v15, v164, v165
    v_lshlrev_b32 v164, 16, v15
    v_and_b32 v165, 0xffff0000, v15
    s_cmp_ge_u32 s50, 43
    s_cbranch_scc1 L_notr
    s_waitcnt vmcnt(8)
    ds_read_b64_tr_b16 v[48:49], v157 offset:0
    ds_read_b64_tr_b16 v[50:51], v157 offset:1024
    ds_read_b64_tr_b16 v[52:53], v157 offset:32
    ds_read_b64_tr_b16 v[54:55], v157 offset:1056
    ds_read_b64_tr_b16 v[56:57], v157 offset:64
    ds_read_b64_tr_b16 v[58:59], v157 offset:1088
    ds_read_b64_tr_b16 v[60:61], v157 offset:96
    ds_read_b64_tr_b16 v[62:63], v157 offset:1120
    ds_read_b64_tr_b16 v[64:65], v157 offset:256
    ds_read_b64_tr_b16 v[66:67], v157 offset:1280
    ds_read_b64_tr_b16 v[68:69], v157 offset:288
    ds_read_b64_tr_b16 v[70:71], v157 offset:1312
    ds_read_b64_tr_b16 v[72:73], v157 offset:320
    ds_read_b64_tr_b16 v[74:75], v157 offset:1344
    ds_read_b64_tr_b16 v[76:77], v157 offset:352
    ds_read_b64_tr_b16 v[78:79], v157 offset:1376
    v_mov_b32 v32, 0x3f803f80
    v_mov_b32 v33, 0x3f803f80
    v_mov_b32 v34, 0x3f803f80
    v_mov_b32 v35, 0x3f803f80
    v_mov_b32 v36, 0x3f803f80
    v_mov_b32 v37, 0x3f803f80
    v_mov_b32 v38, 0x3f803f80
    v_mov_b32 v39, 0x3f803f80
    v_mov_b32 v40, 0x3f803f80
    v_mov_b32 v41, 0x3f803f80
    v_mov_b32 v42, 0x3f803f80
    v_mov_b32 v43, 0x3f803f80
    v_mov_b32 v44, 0x3f803f80
    v_mov_b32 v45, 0x3f803f80
    v_mov_b32 v46, 0x3f803f80
    v_mov_b32 v47, 0x3f803f80
L_notr:
    s_mov_b32 s4, 0xff00ff00
    s_mov_b32 s5, 0xff00ff00
    s_mov_b32 s24, 0xffff0000
    s_mov_b32 s25, 0xffff0000
    s_mov_b32 s51, 2097152
    s_movk_i32 s56, 0xff
    v_mov_b32 v28, 0
    v_mov_b32 v29, 0
    v_mov_b32 v30, 0
    v_mov_b32 v31, 0
    s_waitcnt vmcnt(7)
    v_max_u32 v16, v112, v113
    v_max3_u32 v16, v16, v114, v115
    v_cmp_eq_u32 vcc, -1, v16
    s_cbranch_vccnz L_en_72
    v_mfma_f32_16x16x32_bf16 v[28:31], v[112:115], v[152:155], v[28:31]
    s_bitset0_b32 s56, 0
L_en_72:
    s_waitcnt vmcnt(6)
    v_max_u32 v16, v116, v117
    v_max3_u32 v16, v16, v118, v119
    v_cmp_eq_u32 vcc, -1, v16
    s_cbranch_vccnz L_en_74
    v_mfma_f32_16x16x32_bf16 v[28:31], v[116:119], v[152:155], v[28:31]
    s_bitset0_b32 s56, 1
L_en_74:
    s_waitcnt vmcnt(5)
    v_max_u32 v16, v120, v121
    v_max3_u32 v16, v16, v122, v123
    v_cmp_eq_u32 vcc, -1, v16
    s_cbranch_vccnz L_en_76
    v_mfma_f32_16x16x32_bf16 v[28:31], v[120:123], v[152:155], v[28:31]
    s_bitset0_b32 s56, 2
L_en_76:
    s_waitcnt vmcnt(4)
    v_max_u32 v16, v124, v125
    v_max3_u32 v16, v16, v126, v127
    v_cmp_eq_u32 vcc, -1, v16
    s_cbranch_vccnz L_en_78
    v_mfma_f32_16x16x32_bf16 v[28:31], v[124:127], v[152:155], v[28:31]
    s_bitset0_b32 s56, 3
L_en_78:
    s_waitcnt vmcnt(3)
    v_max_u32 v16, v128, v129
    v_max3_u32 v16, v16, v130, v131
    v_cmp_eq_u32 vcc, -1, v16
    s_cbranch_vccnz L_en_80
    v_mfma_f32_16x16x32_bf16 v[28:31], v[128:131], v[152:155], v[28:31]
    s_bitset0_b32 s56, 4
L_en_80:
    s_waitcnt vmcnt(2)
    v_max_u32 v16, v132, v133
    v_max3_u32 v16, v16, v134, v135
    v_cmp_eq_u32 vcc, -1, v16
    s_cbranch_vccnz L_en_82
    v_mfma_f32_16x16x32_bf16 v[28:31], v[132:135], v[152:155], v[28:31]
    s_bitset0_b32 s56, 5
L_en_82:
    s_waitcnt vmcnt(1)
    v_max_u32 v16, v136, v137
    v_max3_u32 v16, v16, v138, v139
    v_cmp_eq_u32 vcc, -1, v16
    s_cbranch_vccnz L_en_84
    v_mfma_f32_16x16x32_bf16 v[28:31], v[136:139], v[152:155], v[28:31]
    s_bitset0_b32 s56, 6
L_en_84:
    s_waitcnt vmcnt(0)
    v_max_u32 v16, v140, v141
    v_max3_u32 v16, v16, v142, v143
    v_cmp_eq_u32 vcc, -1, v16
    s_cbranch_vccnz L_en_86
    v_mfma_f32_16x16x32_bf16 v[28:31], v[140:143], v[152:155], v[28:31]
    s_bitset0_b32 s56, 7
L_en_86:
    s_cmp_eq_u32 s56, 0
    s_cbranch_scc1 L_e2ok
L_e2retry:
    s_bitcmp1_b32 s56, 0
    s_cbranch_scc0 L_en_88
    v_max_u32 v16, v112, v113
    v_max3_u32 v16, v16, v114, v115
    v_cmp_eq_u32 vcc, -1, v16
    s_cbranch_vccnz L_eb_89
    v_mfma_f32_16x16x32_bf16 v[28:31], v[112:115], v[152:155], v[28:31]
    s_bitset0_b32 s56, 0
    s_branch L_en_88
L_eb_89:
    buffer_load_dwordx4 v[112:115], v156, s[8:11], 0 offen offset:0 sc1
L_en_88:
    s_bitcmp1_b32 s56, 1
    s_cbranch_scc0 L_en_90
    v_max_u32 v16, v116, v117
    v_max3_u32 v16, v16, v118, v119
    v_cmp_eq_u32 vcc, -1, v16
    s_cbranch_vccnz L_eb_91
    v_mfma_f32_16x16x32_bf16 v[28:31], v[116:119], v[152:155], v[28:31]
    s_bitset0_b32 s56, 1
    s_branch L_en_90
L_eb_91:
    s_mov_b32 s52, 4096
    buffer_load_dwordx4 v[116:119], v156, s[8:11], s52 offen offset:0 sc1
L_en_90:
    s_bitcmp1_b32 s56, 2
    s_cbranch_scc0 L_en_92
    v_max_u32 v16, v120, v121
    v_max3_u32 v16, v16, v122, v123
    v_cmp_eq_u32 vcc, -1, v16
    s_cbranch_vccnz L_eb_93
    v_mfma_f32_16x16x32_bf16 v[28:31], v[120:123], v[152:155], v[28:31]
    s_bitset0_b32 s56, 2
    s_branch L_en_92
L_eb_93:
    s_mov_b32 s52, 16384
    buffer_load_dwordx4 v[120:123], v156, s[8:11], s52 offen offset:0 sc1
L_en_92:
    s_bitcmp1_b32 s56, 3
    s_cbranch_scc0 L_en_94
    v_max_u32 v16, v124, v125
    v_max3_u32 v16, v16, v126, v127
    v_cmp_eq_u32 vcc, -1, v16
    s_cbranch_vccnz L_eb_95
    v_mfma_f32_16x16x32_bf16 v[28:31], v[124:127], v[152:155], v[28:31]
    s_bitset0_b32 s56, 3
    s_branch L_en_94
L_eb_95:
    s_mov_b32 s52, 20480
    buffer_load_dwordx4 v[124:127], v156, s[8:11], s52 offen offset:0 sc1
L_en_94:
    s_bitcmp1_b32 s56, 4
    s_cbranch_scc0 L_en_96
    v_max_u32 v16, v128, v129
    v_max3_u32 v16, v16, v130, v131
    v_cmp_eq_u32 vcc, -1, v16
    s_cbranch_vccnz L_eb_97
    v_mfma_f32_16x16x32_bf16 v[28:31], v[128:131], v[152:155], v[28:31]
    s_bitset0_b32 s56, 4
    s_branch L_en_96
L_eb_97:
    s_mov_b32 s52, 32768
    buffer_load_dwordx4 v[128:131], v156, s[8:11], s52 offen offset:0 sc1
L_en_96:
    s_bitcmp1_b32 s56, 5
    s_cbranch_scc0 L_en_98
    v_max_u32 v16, v132, v133
    v_max3_u32 v16, v16, v134, v135
    v_cmp_eq_u32 vcc, -1, v16
    s_cbranch_vccnz L_eb_99
    v_mfma_f32_16x16x32_bf16 v[28:31], v[132:135], v[152:155], v[28:31]
    s_bitset0_b32 s56, 5
    s_branch L_en_98
L_eb_99:
    s_mov_b32 s52, 36864
    buffer_load_dwordx4 v[132:135], v156, s[8:11], s52 offen offset:0 sc1
L_en_98:
    s_bitcmp1_b32 s56, 6
    s_cbranch_scc0 L_en_100
    v_max_u32 v16, v136, v137
    v_max3_u32 v16, v16, v138, v139
    v_cmp_eq_u32 vcc, -1, v16
    s_cbranch_vccnz L_eb_101
    v_mfma_f32_16x16x32_bf16 v[28:31], v[136:139], v[152:155], v[28:31]
    s_bitset0_b32 s56, 6
    s_branch L_en_100
L_eb_101:
    s_mov_b32 s52, 49152
    buffer_load_dwordx4 v[136:139], v156, s[8:11], s52 offen offset:0 sc1
L_en_100:
    s_bitcmp1_b32 s56, 7
    s_cbranch_scc0 L_en_102
    v_max_u32 v16, v140, v141
    v_max3_u32 v16, v16, v142, v143
    v_cmp_eq_u32 vcc, -1, v16
    s_cbranch_vccnz L_eb_103
    v_mfma_f32_16x16x32_bf16 v[28:31], v[140:143], v[152:155], v[28:31]
    s_bitset0_b32 s56, 7
    s_branch L_en_102
L_eb_103:
    s_mov_b32 s52, 53248
    buffer_load_dwordx4 v[140:143], v156, s[8:11], s52 offen offset:0 sc1
L_en_102:
    s_cmp_eq_u32 s56, 0
    s_cbranch_scc1 L_e2ok
    s_sleep 1
    s_waitcnt vmcnt(6)
    s_sub_u32 s51, s51, 1
    s_cbranch_scc0 L_e2retry
L_e2ok:
    s_cmp_ge_u32 s50, 43
    s_nop 4
    v_cndmask_b32 v16, v28, v30, s[4:5]
    v_cndmask_b32 v17, v29, v31, s[4:5]
    v_cvt_pk_bf16_f32 v15, v16, v17
    v_lshlrev_b32 v16, 16, v15
    v_and_b32 v17, 0xffff0000, v15
    v_pk_mul_f32 v[16:17], v[16:17], v[166:167]
    v_cvt_pk_bf16_f32 v15, v16, v17
    v_lshlrev_b32 v16, 16, v15
    v_and_b32 v17, 0xffff0000, v15
    v_pk_add_f32 v[16:17], v[16:17], v[158:159]
    v_cvt_pk_bf16_f32 v15, v16, v17
    v_lshlrev_b32 v16, 16, v15
    v_and_b32 v17, 0xffff0000, v15
    s_cbranch_scc1 L_x1fin
    v_add_f32 v20, v16, v17
    v_mul_f32 v21, v16, v16
    v_fmac_f32 v21, v17, v17
    v_add_f32_dpp v20, v20, v20 row_ror:8 row_mask:0xf bank_mask:0xf
    s_nop 0
    v_add_f32_dpp v21, v21, v21 row_ror:8 row_mask:0xf bank_mask:0xf
    v_add_f32_dpp v20, v20, v20 row_ror:4 row_mask:0xf bank_mask:0xf
    s_nop 0
    v_add_f32_dpp v21, v21, v21 row_ror:4 row_mask:0xf bank_mask:0xf
    v_add_f32_dpp v20, v20, v20 row_ror:2 row_mask:0xf bank_mask:0xf
    s_nop 0
    v_add_f32_dpp v21, v21, v21 row_ror:2 row_mask:0xf bank_mask:0xf
    v_add_f32_dpp v20, v20, v20 row_ror:1 row_mask:0xf bank_mask:0xf
    s_nop 0
    v_add_f32_dpp v21, v21, v21 row_ror:1 row_mask:0xf bank_mask:0xf
    v_add_f32_dpp v20, v20, v20 row_bcast:15 row_mask:0xa bank_mask:0xf
    s_nop 0
    v_add_f32_dpp v21, v21, v21 row_bcast:15 row_mask:0xa bank_mask:0xf
    v_add_f32_dpp v20, v20, v20 row_bcast:31 row_mask:0xc bank_mask:0xf
    s_nop 0
    v_add_f32_dpp v21, v21, v21 row_bcast:31 row_mask:0xc bank_mask:0xf
    ds_write_b64 v148, v[20:21]
    s_waitcnt lgkmcnt(0)
    s_barrier
    ds_read_b128 v[20:23], v161 offset:12288
    ds_read_b128 v[24:27], v161 offset:12304
    buffer_load_dwordx4 v[80:83], v0, s[20:23], 0 offen offset:0 nt
    s_mov_b32 s52, 4096
    buffer_load_dwordx4 v[84:87], v0, s[20:23], s52 offen offset:0 nt
    s_mov_b32 s52, 8192
    buffer_load_dwordx4 v[88:91], v0, s[20:23], s52 offen offset:0 nt
    s_mov_b32 s52, 12288
    buffer_load_dwordx4 v[92:95], v0, s[20:23], s52 offen offset:0 nt
    s_mov_b32 s52, 16384
    buffer_load_dwordx4 v[96:99], v0, s[20:23], s52 offen offset:0 nt
    s_mov_b32 s52, 20480
    buffer_load_dwordx4 v[100:103], v0, s[20:23], s52 offen offset:0 nt
    s_mov_b32 s52, 24576
    buffer_load_dwordx4 v[104:107], v0, s[20:23], s52 offen offset:0 nt
    s_mov_b32 s52, 28672
    buffer_load_dwordx4 v[108:111], v0, s[20:23], s52 offen offset:0 nt
    s_waitcnt lgkmcnt(0)
    v_pk_add_f32 v[20:21], v[20:21], v[22:23]
    v_pk_add_f32 v[24:25], v[24:25], v[26:27]
    v_pk_add_f32 v[20:21], v[20:21], v[24:25]
    v_mul_f32 v20, 0x3b000000, v20
    v_mul_f32 v21, 0x3b000000, v21
    v_fma_f32 v21, -v20, v20, v21
    v_max_f32 v21, 0, v21
    v_cvt_pk_bf16_f32 v22, v20, v21
    v_and_b32 v21, 0xffff0000, v22
    v_add_f32 v21, 0x3727c5ac, v21
    v_cvt_pk_bf16_f32 v21, v21, v21
    v_lshlrev_b32 v21, 16, v21
    v_sqrt_f32 v21, v21
    v_lshlrev_b32 v20, 16, v22
    v_cvt_pk_bf16_f32 v21, v21, v21
    v_lshlrev_b32 v21, 16, v21
    v_rcp_f32 v21, v21
    v_sub_f32 v16, v16, v20
    v_sub_f32 v17, v17, v20
    v_cvt_pk_bf16_f32 v15, v16, v17
    v_lshlrev_b32 v16, 16, v15
    v_and_b32 v17, 0xffff0000, v15
    v_mul_f32 v16, v16, v21
    v_mul_f32 v17, v17, v21
    v_cvt_pk_bf16_f32 v15, v16, v17
    v_lshlrev_b32 v16, 16, v15
    v_and_b32 v17, 0xffff0000, v15
    v_pk_mul_f32 v[16:17], v[16:17], v[164:165]
    v_cvt_pk_bf16_f32 v15, v16, v17
    v_lshlrev_b32 v16, 16, v15
    v_and_b32 v17, 0xffff0000, v15
    v_pk_add_f32 v[16:17], v[16:17], v[162:163]
    v_cvt_pk_bf16_f32 v15, v16, v17
    v_lshlrev_b32 v16, 16, v15
    v_and_b32 v17, 0xffff0000, v15
    v_add_f32 v20, v16, v17
    v_mul_f32 v21, v16, v16
    v_fmac_f32 v21, v17, v17
    v_mov_b32_dpp v32, v15 row_newbcast:0 row_mask:0xf bank_mask:0x3
    v_mov_b32_dpp v33, v15 row_newbcast:1 row_mask:0xf bank_mask:0x3
    v_mov_b32_dpp v34, v15 row_newbcast:2 row_mask:0xf bank_mask:0x3
    v_mov_b32_dpp v35, v15 row_newbcast:3 row_mask:0xf bank_mask:0x3
    v_add_f32_dpp v20, v20, v20 row_ror:8 row_mask:0xf bank_mask:0xf
    v_add_f32_dpp v21, v21, v21 row_ror:8 row_mask:0xf bank_mask:0xf
    v_mfma_f32_16x16x32_bf16 v[24:27], v[32:35], v[48:51], 0
    v_mov_b32_dpp v36, v15 row_newbcast:4 row_mask:0xf bank_mask:0x3
    v_mov_b32_dpp v37, v15 row_newbcast:5 row_mask:0xf bank_mask:0x3
    v_mfma_f32_16x16x32_bf16 v[28:31], v[32:35], v[52:55], 0
    v_mov_b32_dpp v38, v15 row_newbcast:6 row_mask:0xf bank_mask:0x3
    v_mov_b32_dpp v39, v15 row_newbcast:7 row_mask:0xf bank_mask:0x3
    v_add_f32_dpp v20, v20, v20 row_ror:4 row_mask:0xf bank_mask:0xf
    v_add_f32_dpp v21, v21, v21 row_ror:4 row_mask:0xf bank_mask:0xf
    v_mfma_f32_16x16x32_bf16 v[24:27], v[36:39], v[56:59], v[24:27]
    v_mov_b32_dpp v40, v15 row_newbcast:8 row_mask:0xf bank_mask:0x3
    v_mov_b32_dpp v41, v15 row_newbcast:9 row_mask:0xf bank_mask:0x3
    v_mfma_f32_16x16x32_bf16 v[28:31], v[36:39], v[60:63], v[28:31]
    v_mov_b32_dpp v42, v15 row_newbcast:10 row_mask:0xf bank_mask:0x3
    v_mov_b32_dpp v43, v15 row_newbcast:11 row_mask:0xf bank_mask:0x3
    v_add_f32_dpp v20, v20, v20 row_ror:2 row_mask:0xf bank_mask:0xf
    v_add_f32_dpp v21, v21, v21 row_ror:2 row_mask:0xf bank_mask:0xf
    v_mfma_f32_16x16x32_bf16 v[24:27], v[40:43], v[64:67], v[24:27]
    v_mov_b32_dpp v44, v15 row_newbcast:12 row_mask:0xf bank_mask:0x3
    v_mov_b32_dpp v45, v15 row_newbcast:13 row_mask:0xf bank_mask:0x3
    v_mfma_f32_16x16x32_bf16 v[28:31], v[40:43], v[68:71], v[28:31]
    v_mov_b32_dpp v46, v15 row_newbcast:14 row_mask:0xf bank_mask:0x3
    v_mov_b32_dpp v47, v15 row_newbcast:15 row_mask:0xf bank_mask:0x3
    v_add_f32_dpp v20, v20, v20 row_ror:1 row_mask:0xf bank_mask:0xf
    v_add_f32_dpp v21, v21, v21 row_ror:1 row_mask:0xf bank_mask:0xf
    v_mfma_f32_16x16x32_bf16 v[24:27], v[44:47], v[72:75], v[24:27]
    v_add_f32_dpp v20, v20, v20 row_bcast:15 row_mask:0xa bank_mask:0xf
    v_add_f32_dpp v21, v21, v21 row_bcast:15 row_mask:0xa bank_mask:0xf
    v_mfma_f32_16x16x32_bf16 v[28:31], v[44:47], v[76:79], v[28:31]
    v_add_f32_dpp v20, v20, v20 row_bcast:31 row_mask:0xc bank_mask:0xf
    v_add_f32_dpp v21, v21, v21 row_bcast:31 row_mask:0xc bank_mask:0xf
    ds_write_b64 v148, v[20:21] offset:32
    s_nop 4
    v_cndmask_b32 v16, v24, v28, s[24:25]
    ds_write_b32 v149, v16 offset:12800
    s_waitcnt lgkmcnt(0)
    s_barrier
    ds_read_b128 v[20:23], v161 offset:12320
    ds_read_b128 v[24:27], v161 offset:12336
    ds_read_b128 v[16:19], v150 offset:12800
    ds_read_b128 v[28:31], v150 offset:13312
    s_waitcnt lgkmcnt(2)
    v_pk_add_f32 v[20:21], v[20:21], v[22:23]
    v_pk_add_f32 v[24:25], v[24:25], v[26:27]
    v_pk_add_f32 v[20:21], v[20:21], v[24:25]
    v_mul_f32 v20, 0x3b000000, v20
    v_mul_f32 v21, 0x3b000000, v21
    v_fma_f32 v21, -v20, v20, v21
    v_max_f32 v21, 0, v21
    v_cvt_pk_bf16_f32 v22, v20, v21
    v_and_b32 v21, 0xffff0000, v22
    v_add_f32 v21, 0x3727c5ac, v21
    v_cvt_pk_bf16_f32 v21, v21, v21
    v_lshlrev_b32 v21, 16, v21
    v_sqrt_f32 v21, v21
    v_lshlrev_b32 v20, 16, v22
    v_cvt_pk_bf16_f32 v21, v21, v21
    v_lshlrev_b32 v21, 16, v21
    v_rcp_f32 v21, v21
    s_waitcnt lgkmcnt(0)
    v_pk_add_f32 v[16:17], v[16:17], v[18:19]
    v_pk_add_f32 v[28:29], v[28:29], v[30:31]
    v_add_f32 v16, v16, v17
    v_add_f32 v28, v28, v29
    v_fma_f32 v16, -v20, v28, v16
    v_mul_f32 v16, v16, v21
    v_cvt_pk_bf16_f32 v16, v16, v16
    v_lshlrev_b32 v16, 16, v16
    v_add_f32 v16, v16, v160
    v_cvt_pk_bf16_f32 v16, v16, v16
    v_lshlrev_b32 v16, 16, v16
    v_mul_f32 v17, v16, v16
    v_mul_f32 v18, 0xc0135761, v16
    v_mul_f32 v17, 0x3d372713, v17
    v_fma_f32 v17, v17, v18, v18
    v_exp_f32 v17, v17
    s_waitcnt vmcnt(0)
    v_add_f32 v17, 1.0, v17
    v_rcp_f32 v17, v17
    s_nop 0
    v_mul_f32 v16, v16, v17
    v_cvt_pk_bf16_f32 v16, v16, v16
    s_nop 1
    v_and_b32_dpp v20, v16, v8 row_newbcast:0 row_mask:0xf bank_mask:0xf
    v_and_b32_dpp v21, v16, v9 row_newbcast:0 row_mask:0xf bank_mask:0xf
    v_and_b32_dpp v22, v16, v10 row_newbcast:0 row_mask:0xf bank_mask:0xf
    v_and_b32_dpp v23, v16, v11 row_newbcast:0 row_mask:0xf bank_mask:0xf
    v_and_b32_dpp v24, v16, v8 row_newbcast:1 row_mask:0xf bank_mask:0xf
    v_and_b32_dpp v25, v16, v9 row_newbcast:1 row_mask:0xf bank_mask:0xf
    v_and_b32_dpp v26, v16, v10 row_newbcast:1 row_mask:0xf bank_mask:0xf
    v_and_b32_dpp v27, v16, v11 row_newbcast:1 row_mask:0xf bank_mask:0xf
    v_mfma_f32_16x16x32_bf16 v[28:31], v[80:83], v[20:23], 0
    v_and_b32_dpp v20, v16, v8 row_newbcast:2 row_mask:0xf bank_mask:0xf
    v_and_b32_dpp v21, v16, v9 row_newbcast:2 row_mask:0xf bank_mask:0xf
    v_and_b32_dpp v22, v16, v10 row_newbcast:2 row_mask:0xf bank_mask:0xf
    v_and_b32_dpp v23, v16, v11 row_newbcast:2 row_mask:0xf bank_mask:0xf
    v_mfma_f32_16x16x32_bf16 v[28:31], v[84:87], v[24:27], v[28:31]
    v_and_b32_dpp v24, v16, v8 row_newbcast:3 row_mask:0xf bank_mask:0xf
    v_and_b32_dpp v25, v16, v9 row_newbcast:3 row_mask:0xf bank_mask:0xf
    v_and_b32_dpp v26, v16, v10 row_newbcast:3 row_mask:0xf bank_mask:0xf
    v_and_b32_dpp v27, v16, v11 row_newbcast:3 row_mask:0xf bank_mask:0xf
    v_mfma_f32_16x16x32_bf16 v[28:31], v[88:91], v[20:23], v[28:31]
    v_and_b32_dpp v20, v16, v8 row_newbcast:4 row_mask:0xf bank_mask:0xf
    v_and_b32_dpp v21, v16, v9 row_newbcast:4 row_mask:0xf bank_mask:0xf
    v_and_b32_dpp v22, v16, v10 row_newbcast:4 row_mask:0xf bank_mask:0xf
    v_and_b32_dpp v23, v16, v11 row_newbcast:4 row_mask:0xf bank_mask:0xf
    v_mfma_f32_16x16x32_bf16 v[28:31], v[92:95], v[24:27], v[28:31]
    v_and_b32_dpp v24, v16, v8 row_newbcast:5 row_mask:0xf bank_mask:0xf
    v_and_b32_dpp v25, v16, v9 row_newbcast:5 row_mask:0xf bank_mask:0xf
    v_and_b32_dpp v26, v16, v10 row_newbcast:5 row_mask:0xf bank_mask:0xf
    v_and_b32_dpp v27, v16, v11 row_newbcast:5 row_mask:0xf bank_mask:0xf
    v_mfma_f32_16x16x32_bf16 v[28:31], v[96:99], v[20:23], v[28:31]
    v_and_b32_dpp v20, v16, v8 row_newbcast:6 row_mask:0xf bank_mask:0xf
    v_and_b32_dpp v21, v16, v9 row_newbcast:6 row_mask:0xf bank_mask:0xf
    v_and_b32_dpp v22, v16, v10 row_newbcast:6 row_mask:0xf bank_mask:0xf
    v_and_b32_dpp v23, v16, v11 row_newbcast:6 row_mask:0xf bank_mask:0xf
    v_mfma_f32_16x16x32_bf16 v[28:31], v[100:103], v[24:27], v[28:31]
    v_and_b32_dpp v24, v16, v8 row_newbcast:7 row_mask:0xf bank_mask:0xf
    v_and_b32_dpp v25, v16, v9 row_newbcast:7 row_mask:0xf bank_mask:0xf
    v_and_b32_dpp v26, v16, v10 row_newbcast:7 row_mask:0xf bank_mask:0xf
    v_and_b32_dpp v27, v16, v11 row_newbcast:7 row_mask:0xf bank_mask:0xf
    v_mfma_f32_16x16x32_bf16 v[28:31], v[104:107], v[20:23], v[28:31]
    s_nop 0
    v_mfma_f32_16x16x32_bf16 v[28:31], v[108:111], v[24:27], v[28:31]
    s_nop 7
    v_min_u32 v28, -2, v28
    v_min_u32 v29, -2, v29
    v_min_u32 v30, -2, v30
    v_min_u32 v31, -2, v31
    buffer_store_dwordx4 v[28:31], v151, s[8:11], 0 offen sc1
    s_branch L_fin
L_x1fin:
    ds_write_b32 v7, v16 offset:8192
    ds_write_b32 v7, v17 offset:8200
    s_cmpk_lg_u32 s2, 128
    s_cbranch_scc1 L_final
    v_mov_b32 v5, 0
    v_mov_b32 v6, s46
    buffer_store_dword v6, v5, s[8:11], 0 offen sc1
L_final:
    v_and_b32 v5, 0x2000, v156
    v_add_u32 v5, v5, v148
    s_waitcnt lgkmcnt(0)
    ds_read_b32 v12, v150 offset:8192
    ds_read_b32 v13, v150 offset:10240
    v_mov_b32 v48, -1
    v_mov_b32 v49, -1
    v_mov_b32 v50, -1
    v_mov_b32 v51, -1
    v_mov_b32 v52, -1
    v_mov_b32 v53, -1
    v_mov_b32 v54, -1
    v_mov_b32 v55, -1
    v_mov_b32 v56, -1
    v_mov_b32 v57, -1
    v_mov_b32 v58, -1
    v_mov_b32 v59, -1
    v_mov_b32 v60, -1
    v_mov_b32 v61, -1
    v_mov_b32 v62, -1
    v_mov_b32 v63, -1
    v_mov_b32 v64, -1
    v_mov_b32 v65, -1
    v_mov_b32 v66, -1
    v_mov_b32 v67, -1
    v_mov_b32 v68, 0
    v_mov_b32 v69, 0
    v_mov_b32 v70, 0
    v_mov_b32 v71, 0
    s_mov_b64 exec, 0xffffff
    v_mov_b32 v68, -1
    v_mov_b32 v69, -1
    v_mov_b32 v70, -1
    v_mov_b32 v71, -1
    s_mov_b64 exec, -1
    s_mov_b32 s51, 2097152
L_poll_104:
    s_mov_b32 s52, 917504
    buffer_load_dwordx4 v[48:51], v5, s[8:11], s52 offen offset:0 sc1
    s_mov_b32 s52, 950272
    buffer_load_dwordx4 v[52:55], v5, s[8:11], s52 offen offset:0 sc1
    s_mov_b32 s52, 983040
    buffer_load_dwordx4 v[56:59], v5, s[8:11], s52 offen offset:0 sc1
    s_mov_b32 s52, 1015808
    buffer_load_dwordx4 v[60:63], v5, s[8:11], s52 offen offset:0 sc1
    s_mov_b32 s52, 1048576
    buffer_load_dwordx4 v[64:67], v5, s[8:11], s52 offen offset:0 sc1
    s_mov_b64 exec, 0xffffff
    s_mov_b32 s52, 1081344
    buffer_load_dwordx4 v[68:71], v5, s[8:11], s52 offen offset:0 sc1
    s_mov_b64 exec, -1
    s_waitcnt vmcnt(12)
    v_max_u32 v15, v48, v49
    v_max3_u32 v15, v15, v50, v51
    v_max3_u32 v15, v15, v52, v53
    v_max3_u32 v15, v15, v54, v55
    v_max3_u32 v15, v15, v56, v57
    v_max3_u32 v15, v15, v58, v59
    v_max3_u32 v15, v15, v60, v61
    v_max3_u32 v15, v15, v62, v63
    v_max3_u32 v15, v15, v64, v65
    v_max3_u32 v15, v15, v66, v67
    v_max3_u32 v15, v15, v68, v69
    v_max3_u32 v15, v15, v70, v71
    v_cmp_eq_u32 vcc, -1, v15
    s_cbranch_vccz L_ok_105
    s_sub_u32 s51, s51, 1
    s_cbranch_scc0 L_poll_104
L_ok_105:
    v_pk_add_f32 v[72:73], v[48:49], v[52:53]
    v_pk_add_f32 v[76:77], v[56:57], v[60:61]
    v_pk_add_f32 v[80:81], v[64:65], v[68:69]
    v_pk_add_f32 v[74:75], v[50:51], v[54:55]
    v_pk_add_f32 v[78:79], v[58:59], v[62:63]
    v_pk_add_f32 v[82:83], v[66:67], v[70:71]
    v_pk_add_f32 v[72:73], v[72:73], v[76:77]
    v_pk_add_f32 v[74:75], v[74:75], v[78:79]
    v_pk_add_f32 v[72:73], v[72:73], v[80:81]
    v_pk_add_f32 v[74:75], v[74:75], v[82:83]
    s_nop 1
    v_permlane32_swap_b32 v72, v74
    v_permlane32_swap_b32 v73, v75
    v_add_f32 v72, v72, v74
    v_add_f32 v73, v73, v75
    s_nop 1
    v_permlane16_swap_b32 v72, v73
    v_add_f32 v72, v72, v73
    s_nop 1
    v_add_f32_dpp v72, v72, v72 row_ror:8 row_mask:0xf bank_mask:0xf
    s_waitcnt lgkmcnt(0)
    v_lshlrev_b32 v14, 16, v151
    v_cvt_pk_bf16_f32 v72, v72, v72
    v_lshlrev_b32 v72, 16, v72
    v_add_f32 v72, v72, v14
    v_cvt_pk_bf16_f32 v72, v72, v72
    v_lshlrev_b32 v72, 16, v72
    v_mul_f32 v72, v72, v13
    v_cvt_pk_bf16_f32 v72, v72, v72
    v_lshlrev_b32 v72, 16, v72
    v_add_f32 v72, v72, v12
    v_cvt_pk_bf16_f32 v72, v72, v72
    global_store_short v149, v72, s[40:41]
L_fin:
L_end:
    s_endpgm
.fill 64, 4, 0xbf810000
.section .rodata,"a"
.p2align 6
.amdhsa_kernel adaLN_cond__mha_block_cached__mixer_channel_mlp__decode_kernel
.amdhsa_next_free_vgpr 168
.amdhsa_next_free_sgpr 102
.amdhsa_accum_offset 168
.amdhsa_group_segment_fixed_size 0
.amdhsa_kernarg_size 120
.amdhsa_user_sgpr_count 2
.amdhsa_user_sgpr_kernarg_segment_ptr 1
.amdhsa_system_sgpr_workgroup_id_x 1
.amdhsa_float_denorm_mode_32 3
.end_amdhsa_kernel
```
